```python
import torch

def _softmax(x, axis=-1):
    return torch.softmax(x, dim=axis)
def _gelu(x):
    return torch.nn.functional.gelu(x, approximate="tanh")
def _silu(x):
    return torch.nn.functional.silu(x)
def _sigmoid(x):
    return torch.sigmoid(x)
def _layernorm(x, axis=-1, eps=1e-5):
    m = x.mean(dim=axis, keepdim=True)
    v = x.var(dim=axis, keepdim=True, unbiased=False)
    return (x - m) / torch.sqrt(v + eps)
def _scatter_add(tgt, idx, src, axis=0):
    return tgt.clone().index_add_(axis, idx, src)
def _segment_sum(src, seg, n):
    out = torch.zeros((n,) + src.shape[1:], dtype=src.dtype)
    return out.index_add_(0, seg, src)
def _pad(x, pw):
    flat = tuple(v for pair in reversed(pw) for v in pair)
    return torch.nn.functional.pad(x, flat)

kernel_name = 'standalone__deep_cross_xdeepfm__recsys'

def setup_inputs():

    _w = (lambda a: (lambda t: t.to(torch.bfloat16) if t.is_floating_point() else t)(torch.as_tensor(a)))
    B, F, D, L = 4096, 26, 16, 3
    V = min(1000000, 100000)
    Din = F * D
    return {
        "idx": _w((lambda lo, hi, *s: torch.randint(lo, hi, s))(0, V, B, F).to(torch.int64)),
        "table": _w((lambda *s: torch.randn(*s, dtype=torch.bfloat16) * 0.8)(V, D)),
        "ws_cin": _w((lambda *s: torch.randn(*s, dtype=torch.bfloat16) * 0.2)(L, F, F, F) * (1.0 / F)),
        "w_cin_out": _w((lambda *s: torch.randn(*s, dtype=torch.bfloat16) * 0.2)(L * F) * ((L * F) ** -0.5)),
        "w_dnn1": _w((lambda *s: torch.randn(*s, dtype=torch.bfloat16) * 0.8)(Din, Din) * (Din ** -0.5)),
        "b_dnn1": _w((lambda *s: torch.randn(*s, dtype=torch.bfloat16) * 3.2)(Din) * 0.1),
        "w_dnn2": _w((lambda *s: torch.randn(*s, dtype=torch.bfloat16) * 0.2)(Din) * (Din ** -0.5)),
        "b_out": _w((lambda *s: torch.randn(*s, dtype=torch.bfloat16) * 0.4)(1)),
    }

def reference(idx, table, ws_cin, w_cin_out, w_dnn1, b_dnn1, w_dnn2, b_out):
    x0 = table[idx]
    B = x0.shape[0]
    L = ws_cin.shape[0]
    xk = x0
    pooled = []
    for l in range(L):
        xk = torch.einsum('bid,bjd,hij->bhd', xk, x0, ws_cin[l])
        pooled.append(xk.sum(axis=-1))
    p_plus = torch.stack(pooled, axis=1).reshape(B, -1)
    logit_cin = p_plus @ w_cin_out
    h = x0.reshape(B, -1)
    h = _gelu(h @ w_dnn1 + b_dnn1)
    logit_dnn = h @ w_dnn2
    return logit_cin + logit_dnn + b_out
```

```asm
; @launch grid=(256,1,1) block=(512,1,1) lds=163840
.amdgcn_target "amdgcn-amd-amdhsa--gfx950"
.text
.globl standalone__deep_cross_xdeepfm__recsys_kernel
.p2align 8
.type standalone__deep_cross_xdeepfm__recsys_kernel,@function
standalone__deep_cross_xdeepfm__recsys_kernel:
    s_cmp_ge_u32 s2, 256
    s_cbranch_scc1 L_end
    s_load_dwordx16 s[4:19], s[0:1], 0
    v_lshrrev_b32 v1, 6, v0
    v_and_b32 v0, 63, v0
    v_readfirstlane_b32 s64, v1
    s_bfe_u32 s93, s2, 0x50003
    s_getpc_b64 s[88:89]
    s_lshl_b32 s68, s93, 3
    s_nop 0
    s_add_u32 s68, s68, s64
    s_lshl_b32 s69, s68, 7
    s_min_u32 s69, s69, L_end-standalone__deep_cross_xdeepfm__recsys_kernel
    s_and_b32 s88, s88, 0xffffff00
    v_mov_b32 v122, s69
    global_load_dword v186, v122, s[88:89]
    s_mul_i32 s69, s68, 11
    s_lshl_b32 s70, s68, 2
    v_add_u32 v123, s69, v0
    v_add_u32 v124, s70, v0
    v_lshlrev_b32 v123, 7, v123
    v_lshlrev_b32 v124, 7, v124
    s_and_b32 s65, s64, 3
    s_lshl_b32 s68, s2, 4
    s_lshl_b32 s69, s65, 2
    s_add_u32 s68, s68, s69
    s_mul_i32 s68, s68, 104
    v_lshrrev_b32 v125, 1, v0
    v_lshlrev_b32 v125, 2, v125
    v_add_u32 v125, s68, v125
    s_cmp_ge_u32 s64, 4
    s_waitcnt lgkmcnt(0)
    s_cbranch_scc0 L_eN
    s_mov_b32 s24, s4
    s_mov_b32 s25, s5
    s_mov_b32 s26, 425984
    s_mov_b32 s27, 0x20000
    buffer_load_dword v68, v125, s[24:27], 0 offen offset:0
    buffer_load_dword v69, v125, s[24:27], 0 offen offset:104
    buffer_load_dword v70, v125, s[24:27], 0 offen offset:208
    buffer_load_dword v71, v125, s[24:27], 0 offen offset:312
L_eN:
    s_mov_b32 s32, s8
    s_mov_b32 s33, s9
    s_mov_b32 s34, 105456
    s_mov_b32 s35, 0x20000
    s_mov_b32 s36, s12
    s_mov_b32 s37, s13
    s_mov_b32 s38, 346112
    s_mov_b32 s39, 0x20000
    s_mov_b32 exec_lo, 0xf
    s_mov_b32 exec_hi, 0
    buffer_load_dword v186, v124, s[32:35], 0 offen
    s_mov_b32 exec_lo, 0x7ff
    buffer_load_dword v186, v123, s[36:39], 0 offen
    s_mov_b64 exec, -1
    v_lshrrev_b32 v122, 5, v0
    v_and_b32 v123, 1, v0
    v_lshlrev_b32 v123, 4, v123
    s_movk_i32 s84, 1352
    v_bfe_u32 v124, v0, 1, 4
    v_mad_u32_u24 v123, v122, s84, v123
    v_xor_b32 v124, v124, v122
    s_mul_i32 s67, s65, 7
    s_cmp_eq_u32 s65, 3
    s_cselect_b32 s68, 1, 0
    s_sub_u32 s67, s67, s68
    v_and_b32 v122, 1, v124
    v_lshl_add_u32 v123, v122, 5, v123
    s_mul_i32 s82, s65, 13312
    s_mul_i32 s68, s65, 208
    s_add_u32 s68, s68, 70304
    s_mul_i32 s69, s67, 52
    s_add_u32 s69, s69, 35152
    s_movk_i32 s70, 832
    s_cmp_ge_u32 s64, 4
    s_cselect_b32 s83, s69, s68
    s_cselect_b32 s85, 208, s70
    s_movk_i32 s70, 20992
    s_cselect_b32 s68, 74240, s70
    s_add_u32 s82, s82, s68
    v_lshrrev_b32 v122, 3, v124
    v_mad_u32_u24 v123, v122, s85, v123
    v_bfe_u32 v124, v124, 1, 2
    s_mov_b32 m0, s82
    v_mad_u32_u24 v182, v124, 52, v123
    s_movk_i32 s71, 2704
    s_movk_i32 s70, 1024
    v_xor_b32 v122, 1, v124
    v_mad_u32_u24 v183, v122, 52, v123
    v_xor_b32 v122, 2, v124
    v_mad_u32_u24 v184, v122, 52, v123
    v_xor_b32 v122, 3, v124
    v_mad_u32_u24 v185, v122, 52, v123
    buffer_load_dwordx4 v182, s[32:35], s83 offen lds
    s_add_u32 m0, m0, s70
    s_add_u32 s83, s83, s71
    buffer_load_dwordx4 v183, s[32:35], s83 offen lds
    s_add_u32 m0, m0, s70
    s_add_u32 s83, s83, s71
    buffer_load_dwordx4 v184, s[32:35], s83 offen lds
    s_add_u32 m0, m0, s70
    s_add_u32 s83, s83, s71
    buffer_load_dwordx4 v185, s[32:35], s83 offen lds
    s_add_u32 m0, m0, s70
    s_add_u32 s83, s83, s71
    buffer_load_dwordx4 v182, s[32:35], s83 offen lds
    s_add_u32 m0, m0, s70
    s_add_u32 s83, s83, s71
    buffer_load_dwordx4 v183, s[32:35], s83 offen lds
    s_add_u32 m0, m0, s70
    s_add_u32 s83, s83, s71
    buffer_load_dwordx4 v184, s[32:35], s83 offen lds
    s_add_u32 m0, m0, s70
    s_add_u32 s83, s83, s71
    buffer_load_dwordx4 v185, s[32:35], s83 offen lds
    s_add_u32 m0, m0, s70
    s_add_u32 s83, s83, s71
    buffer_load_dwordx4 v182, s[32:35], s83 offen lds
    s_add_u32 m0, m0, s70
    s_add_u32 s83, s83, s71
    buffer_load_dwordx4 v183, s[32:35], s83 offen lds
    s_add_u32 m0, m0, s70
    s_add_u32 s83, s83, s71
    buffer_load_dwordx4 v184, s[32:35], s83 offen lds
    s_add_u32 m0, m0, s70
    s_add_u32 s83, s83, s71
    buffer_load_dwordx4 v185, s[32:35], s83 offen lds
    s_add_u32 m0, m0, s70
    s_add_u32 s83, s83, s71
    buffer_load_dwordx4 v182, s[32:35], s83 offen lds
    s_load_dwordx2 s[20:21], s[0:1], 64
    s_load_dword s66, s[18:19], 0
    v_and_b32 v142, 15, v0
    v_lshrrev_b32 v143, 4, v0
    v_bfe_u32 v144, v0, 2, 2
    v_and_b32 v145, 3, v0
    s_cmp_lt_u32 s64, 4
    s_cbranch_scc1 L_Upath
    s_mov_b32 s80, -1
    s_mov_b32 s81, 0x000fffff
    v_lshlrev_b32 v123, 4, v143
    v_mad_u32_u24 v72, v142, 52, v123
    v_cmp_gt_u32 vcc, 10, v142
    v_add_u32 v73, 832, v72
    v_mov_b32 v124, 0x7ff00000
    v_cndmask_b32 v73, v124, v73, vcc
    s_mul_i32 s68, s67, 1352
    s_mov_b32 s40, s10
    s_mov_b32 s41, s11
    s_mov_b32 s42, 52
    s_mov_b32 s43, 0x20000
    s_mov_b32 s52, s14
    s_mov_b32 s53, s15
    s_mov_b32 s54, 832
    s_mov_b32 s55, 0x20000
    s_mov_b32 s56, s16
    s_mov_b32 s57, s17
    s_mov_b32 s58, 832
    s_mov_b32 s59, 0x20000
    v_lshlrev_b32 v136, 4, v0
    s_cmp_eq_u32 s65, 0
    s_cbranch_scc0 L_sm1
    s_mov_b32 exec_lo, 15
    s_mov_b32 exec_hi, 0
    s_mov_b32 m0, 156160
    s_nop 0
    buffer_load_dwordx4 v136, s[40:43], 0 offen lds
    s_branch L_smdone
L_sm1:
    s_mov_b64 exec, s[80:81]
    s_cmp_eq_u32 s65, 1
    s_cbranch_scc0 L_sm2
    s_mov_b32 m0, 156224
    s_nop 0
    buffer_load_dwordx4 v136, s[52:55], 0 offen lds
    s_branch L_smdone
L_sm2:
    s_cmp_eq_u32 s65, 2
    s_cbranch_scc0 L_smdone
    s_mov_b32 m0, 157056
    s_nop 0
    buffer_load_dwordx4 v136, s[56:59], 0 offen lds
L_smdone:
    s_mov_b64 exec, -1
    s_add_u32 s69, s68, 0
    buffer_load_dwordx4 v[2:5], v72, s[32:35], s69 offen
    buffer_load_dwordx4 v[6:9], v73, s[32:35], s69 offen
    s_add_u32 s69, s68, 1352
    buffer_load_dwordx4 v[10:13], v72, s[32:35], s69 offen
    buffer_load_dwordx4 v[14:17], v73, s[32:35], s69 offen
    s_add_u32 s69, s68, 2704
    buffer_load_dwordx4 v[18:21], v72, s[32:35], s69 offen
    buffer_load_dwordx4 v[22:25], v73, s[32:35], s69 offen
    s_add_u32 s69, s68, 4056
    buffer_load_dwordx4 v[26:29], v72, s[32:35], s69 offen
    buffer_load_dwordx4 v[30:33], v73, s[32:35], s69 offen
    s_add_u32 s69, s68, 5408
    buffer_load_dwordx4 v[34:37], v72, s[32:35], s69 offen
    buffer_load_dwordx4 v[38:41], v73, s[32:35], s69 offen
    s_add_u32 s69, s68, 6760
    buffer_load_dwordx4 v[42:45], v72, s[32:35], s69 offen
    buffer_load_dwordx4 v[46:49], v73, s[32:35], s69 offen
    s_cmp_ge_u32 s65, 2
    s_cbranch_scc1 L_w0done
    s_add_u32 s69, s68, 8112
    buffer_load_dwordx4 v[50:53], v72, s[32:35], s69 offen
    buffer_load_dwordx4 v[54:57], v73, s[32:35], s69 offen
L_w0done:
    s_waitcnt vmcnt(27)
    s_mov_b32 s28, s6
    s_mov_b32 s29, s7
    s_mov_b32 s30, 3200000
    s_mov_b32 s31, 0x20000
    v_and_b32 v122, 1, v0
    v_lshlrev_b32 v122, 4, v122
    v_lshl_add_u32 v68, v68, 5, v122
    v_lshl_add_u32 v69, v69, 5, v122
    v_lshl_add_u32 v70, v70, 5, v122
    v_lshl_add_u32 v71, v71, 5, v122
    s_mul_i32 s68, s65, 3648
    s_mov_b64 exec, s[80:81]
    s_add_u32 m0, s68, 127488
    s_nop 0
    buffer_load_dwordx4 v68, s[28:31], 0 offen lds
    s_add_u32 m0, s68, 128400
    s_nop 0
    buffer_load_dwordx4 v69, s[28:31], 0 offen lds
    s_add_u32 m0, s68, 129312
    s_nop 0
    buffer_load_dwordx4 v70, s[28:31], 0 offen lds
    s_add_u32 m0, s68, 130224
    s_nop 0
    buffer_load_dwordx4 v71, s[28:31], 0 offen lds
    s_mov_b64 exec, -1
    s_waitcnt vmcnt(13)
    s_barrier
    v_lshrrev_b32 v132, 4, v0
    v_mul_u32_u24 v132, 912, v132
    v_lshl_add_u32 v132, v142, 2, v132
    s_mul_i32 s84, s65, 3648
    s_add_u32 s84, s84, 128320
    v_add_u32 v132, s84, v132
    v_cmp_gt_u32 vcc, 8, v142
    v_mov_b32 v133, 0x3f803f80
    v_mov_b32 v134, 158912
    v_mov_b32 v135, 0
    v_cndmask_b32 v133, 0, v133, vcc
    ds_write_b32 v132, v133
    ds_write_b32 v134, v135
    ds_write_b32 v134, v135 offset:4
    v_and_b32 v132, 1, v0
    v_lshlrev_b32 v132, 4, v132
    v_mov_b32 v133, 0x3f80
    v_lshlrev_b32 v133, v132, v133
    s_mov_b32 s73, 0
    s_mov_b32 s74, 0
    s_mov_b32 s72, 0x3000003
    v_cndmask_b32 v60, 0, v133, s[72:73]
    s_mov_b32 s75, 0x3000003
    v_cndmask_b32 v64, 0, v133, s[74:75]
    s_mov_b32 s72, 0xc00000c
    v_cndmask_b32 v61, 0, v133, s[72:73]
    s_mov_b32 s75, 0xc
    v_cndmask_b32 v65, 0, v133, s[74:75]
    s_mov_b32 s72, 0x30000030
    v_cndmask_b32 v62, 0, v133, s[72:73]
    s_mov_b32 s75, 0x30
    v_cndmask_b32 v66, 0, v133, s[74:75]
    s_mov_b32 s72, 0xc00000c0
    v_cndmask_b32 v63, 0, v133, s[72:73]
    s_mov_b32 s75, 0xc0
    v_cndmask_b32 v67, 0, v133, s[74:75]
    v_bfe_u32 v132, v142, 1, 1
    v_mul_u32_u24 v133, 420, v132
    v_and_b32 v134, 1, v142
    v_lshl_add_u32 v133, v134, 3, v133
    s_lshl_b32 s84, s67, 4
    v_lshrrev_b32 v134, 2, v142
    v_add_u32 v132, 1, v143
    v_mul_u32_u24 v132, v132, v143
    v_cmp_le_u32 s[72:73], v134, v143
    v_lshrrev_b32 v132, 1, v132
    v_cmp_ge_u32 s[74:75], 2, v143
    v_add_u32 v132, v132, v134
    s_movk_i32 s86, 848
    v_add_u32 v133, s84, v133
    v_lshlrev_b32 v136, 2, v0
    v_mad_u32_u24 v135, v132, s86, v133
    s_and_b64 s[76:77], s[72:73], s[74:75]
    v_add_u32 v136, 262144, v136
    s_movk_i32 s85, 3392
    v_cndmask_b32 v146, v136, v135, s[72:73]
    v_mad_u32_u24 v135, v143, s85, v135
    v_xor_b32 v149, 4, v146
    v_add_u32 v135, 8480, v135
    v_cndmask_b32 v147, v136, v135, s[74:75]
    v_add_u32 v135, 3392, v135
    v_xor_b32 v150, 4, v147
    v_cndmask_b32 v148, v136, v135, s[76:77]
    v_xor_b32 v151, 4, v148
    v_and_b32 v132, 31, v0
    v_lshlrev_b32 v132, 4, v132
    v_lshrrev_b32 v133, 5, v0
    s_movk_i32 s85, 416
    v_mad_u32_u24 v100, v133, s85, v132
    v_lshrrev_b32 v133, 1, v143
    v_and_b32 v134, 1, v143
    s_movk_i32 s85, 912
    v_lshlrev_b32 v132, 1, v133
    v_xor_b32 v132, v132, v144
    v_lshlrev_b32 v132, 5, v132
    v_lshl_add_u32 v132, v145, 3, v132
    v_mad_u32_u24 v132, v134, s85, v132
    s_mul_i32 s84, s65, 3648
    s_add_u32 s84, s84, 127488
    v_add_u32 v101, s84, v132
    s_waitcnt vmcnt(14)
    v_mfma_f32_16x16x32_bf16 v[152:155], v[2:5], v[60:63], 0
    v_mfma_f32_16x16x32_bf16 v[156:159], v[6:9], v[60:63], 0
    v_mfma_f32_16x16x32_bf16 v[160:163], v[6:9], v[64:67], 0
    v_mfma_f32_16x16x32_bf16 v[152:155], v[60:63], v[2:5], v[152:155]
    v_mfma_f32_16x16x32_bf16 v[156:159], v[64:67], v[2:5], v[156:159]
    v_mfma_f32_16x16x32_bf16 v[160:163], v[64:67], v[6:9], v[160:163]
    s_waitcnt vmcnt(12)
    v_mfma_f32_16x16x32_bf16 v[164:167], v[10:13], v[60:63], 0
    s_nop 3
    v_cvt_pk_bf16_f32 v176, v152, v153
    v_cvt_pk_bf16_f32 v177, v154, v155
    v_mfma_f32_16x16x32_bf16 v[168:171], v[14:17], v[60:63], 0
    v_cvt_pk_bf16_f32 v178, v156, v157
    v_cvt_pk_bf16_f32 v179, v158, v159
    v_mfma_f32_16x16x32_bf16 v[172:175], v[14:17], v[64:67], 0
    v_cvt_pk_bf16_f32 v180, v160, v161
    v_cvt_pk_bf16_f32 v181, v162, v163
    v_mfma_f32_16x16x32_bf16 v[164:167], v[60:63], v[10:13], v[164:167]
    ds_write_b32 v146, v176 offset:0
    ds_write_b32 v149, v177 offset:0
    v_mfma_f32_16x16x32_bf16 v[168:171], v[64:67], v[10:13], v[168:171]
    ds_write_b32 v147, v178 offset:0
    ds_write_b32 v150, v179 offset:0
    v_mfma_f32_16x16x32_bf16 v[172:175], v[64:67], v[14:17], v[172:175]
    ds_write_b32 v148, v180 offset:0
    ds_write_b32 v151, v181 offset:0
    s_waitcnt vmcnt(10)
    v_mfma_f32_16x16x32_bf16 v[152:155], v[18:21], v[60:63], 0
    v_cvt_pk_bf16_f32 v176, v164, v165
    v_cvt_pk_bf16_f32 v177, v166, v167
    v_mfma_f32_16x16x32_bf16 v[156:159], v[22:25], v[60:63], 0
    v_cvt_pk_bf16_f32 v178, v168, v169
    v_cvt_pk_bf16_f32 v179, v170, v171
    v_mfma_f32_16x16x32_bf16 v[160:163], v[22:25], v[64:67], 0
    v_cvt_pk_bf16_f32 v180, v172, v173
    v_cvt_pk_bf16_f32 v181, v174, v175
    v_mfma_f32_16x16x32_bf16 v[152:155], v[60:63], v[18:21], v[152:155]
    ds_write_b32 v146, v176 offset:16
    ds_write_b32 v149, v177 offset:16
    v_mfma_f32_16x16x32_bf16 v[156:159], v[64:67], v[18:21], v[156:159]
    ds_write_b32 v147, v178 offset:16
    ds_write_b32 v150, v179 offset:16
    v_mfma_f32_16x16x32_bf16 v[160:163], v[64:67], v[22:25], v[160:163]
    ds_write_b32 v148, v180 offset:16
    ds_write_b32 v151, v181 offset:16
    s_waitcnt vmcnt(8)
    v_mfma_f32_16x16x32_bf16 v[164:167], v[26:29], v[60:63], 0
    v_cvt_pk_bf16_f32 v176, v152, v153
    v_cvt_pk_bf16_f32 v177, v154, v155
    v_mfma_f32_16x16x32_bf16 v[168:171], v[30:33], v[60:63], 0
    v_cvt_pk_bf16_f32 v178, v156, v157
    v_cvt_pk_bf16_f32 v179, v158, v159
    v_mfma_f32_16x16x32_bf16 v[172:175], v[30:33], v[64:67], 0
    v_cvt_pk_bf16_f32 v180, v160, v161
    v_cvt_pk_bf16_f32 v181, v162, v163
    v_mfma_f32_16x16x32_bf16 v[164:167], v[60:63], v[26:29], v[164:167]
    ds_write_b32 v146, v176 offset:32
    ds_write_b32 v149, v177 offset:32
    v_mfma_f32_16x16x32_bf16 v[168:171], v[64:67], v[26:29], v[168:171]
    ds_write_b32 v147, v178 offset:32
    ds_write_b32 v150, v179 offset:32
    v_mfma_f32_16x16x32_bf16 v[172:175], v[64:67], v[30:33], v[172:175]
    ds_write_b32 v148, v180 offset:32
    ds_write_b32 v151, v181 offset:32
    s_waitcnt vmcnt(6)
    v_mfma_f32_16x16x32_bf16 v[152:155], v[34:37], v[60:63], 0
    v_cvt_pk_bf16_f32 v176, v164, v165
    v_cvt_pk_bf16_f32 v177, v166, v167
    v_mfma_f32_16x16x32_bf16 v[156:159], v[38:41], v[60:63], 0
    v_cvt_pk_bf16_f32 v178, v168, v169
    v_cvt_pk_bf16_f32 v179, v170, v171
    v_mfma_f32_16x16x32_bf16 v[160:163], v[38:41], v[64:67], 0
    v_cvt_pk_bf16_f32 v180, v172, v173
    v_cvt_pk_bf16_f32 v181, v174, v175
    v_mfma_f32_16x16x32_bf16 v[152:155], v[60:63], v[34:37], v[152:155]
    ds_write_b32 v146, v176 offset:48
    ds_write_b32 v149, v177 offset:48
    v_mfma_f32_16x16x32_bf16 v[156:159], v[64:67], v[34:37], v[156:159]
    ds_write_b32 v147, v178 offset:48
    ds_write_b32 v150, v179 offset:48
    v_mfma_f32_16x16x32_bf16 v[160:163], v[64:67], v[38:41], v[160:163]
    ds_write_b32 v148, v180 offset:48
    ds_write_b32 v151, v181 offset:48
    s_waitcnt vmcnt(4)
    v_mfma_f32_16x16x32_bf16 v[164:167], v[42:45], v[60:63], 0
    v_cvt_pk_bf16_f32 v176, v152, v153
    v_cvt_pk_bf16_f32 v177, v154, v155
    v_mfma_f32_16x16x32_bf16 v[168:171], v[46:49], v[60:63], 0
    v_cvt_pk_bf16_f32 v178, v156, v157
    v_cvt_pk_bf16_f32 v179, v158, v159
    v_mfma_f32_16x16x32_bf16 v[172:175], v[46:49], v[64:67], 0
    v_cvt_pk_bf16_f32 v180, v160, v161
    v_cvt_pk_bf16_f32 v181, v162, v163
    v_mfma_f32_16x16x32_bf16 v[164:167], v[60:63], v[42:45], v[164:167]
    ds_write_b32 v146, v176 offset:64
    ds_write_b32 v149, v177 offset:64
    v_mfma_f32_16x16x32_bf16 v[168:171], v[64:67], v[42:45], v[168:171]
    ds_write_b32 v147, v178 offset:64
    ds_write_b32 v150, v179 offset:64
    v_mfma_f32_16x16x32_bf16 v[172:175], v[64:67], v[46:49], v[172:175]
    ds_write_b32 v148, v180 offset:64
    ds_write_b32 v151, v181 offset:64
    s_cmp_ge_u32 s65, 2
    s_cbranch_scc1 L_plast
    s_waitcnt vmcnt(4)
    v_mfma_f32_16x16x32_bf16 v[152:155], v[50:53], v[60:63], 0
    v_cvt_pk_bf16_f32 v176, v164, v165
    v_cvt_pk_bf16_f32 v177, v166, v167
    v_mfma_f32_16x16x32_bf16 v[156:159], v[54:57], v[60:63], 0
    v_cvt_pk_bf16_f32 v178, v168, v169
    v_cvt_pk_bf16_f32 v179, v170, v171
    v_mfma_f32_16x16x32_bf16 v[160:163], v[54:57], v[64:67], 0
    v_cvt_pk_bf16_f32 v180, v172, v173
    v_cvt_pk_bf16_f32 v181, v174, v175
    v_mfma_f32_16x16x32_bf16 v[152:155], v[60:63], v[50:53], v[152:155]
    ds_write_b32 v146, v176 offset:80
    ds_write_b32 v149, v177 offset:80
    v_mfma_f32_16x16x32_bf16 v[156:159], v[64:67], v[50:53], v[156:159]
    ds_write_b32 v147, v178 offset:80
    ds_write_b32 v150, v179 offset:80
    v_mfma_f32_16x16x32_bf16 v[160:163], v[64:67], v[54:57], v[160:163]
    ds_write_b32 v148, v180 offset:80
    ds_write_b32 v151, v181 offset:80
    v_cvt_pk_bf16_f32 v176, v152, v153
    v_cvt_pk_bf16_f32 v177, v154, v155
    s_nop 0
    v_cvt_pk_bf16_f32 v178, v156, v157
    v_cvt_pk_bf16_f32 v179, v158, v159
    s_nop 0
    v_cvt_pk_bf16_f32 v180, v160, v161
    v_cvt_pk_bf16_f32 v181, v162, v163
    ds_write_b32 v146, v176 offset:96
    ds_write_b32 v149, v177 offset:96
    ds_write_b32 v147, v178 offset:96
    ds_write_b32 v150, v179 offset:96
    ds_write_b32 v148, v180 offset:96
    ds_write_b32 v151, v181 offset:96
    s_branch L_pend
L_plast:
    v_cvt_pk_bf16_f32 v176, v164, v165
    v_cvt_pk_bf16_f32 v177, v166, v167
    v_cvt_pk_bf16_f32 v178, v168, v169
    v_cvt_pk_bf16_f32 v179, v170, v171
    v_cvt_pk_bf16_f32 v180, v172, v173
    v_cvt_pk_bf16_f32 v181, v174, v175
    ds_write_b32 v146, v176 offset:80
    ds_write_b32 v149, v177 offset:80
    ds_write_b32 v147, v178 offset:80
    ds_write_b32 v150, v179 offset:80
    ds_write_b32 v148, v180 offset:80
    ds_write_b32 v151, v181 offset:80
L_pend:
    s_waitcnt lgkmcnt(0)
    s_barrier
    v_lshrrev_b32 v132, 5, v0
    v_lshlrev_b32 v132, 3, v132
    v_add_u32 v132, 156160, v132
    ds_read_b64 v[104:105], v132 offset:0
    ds_read_b64 v[106:107], v132 offset:16
    ds_read_b64 v[108:109], v132 offset:32
    ds_read_b64 v[110:111], v132 offset:48
    s_waitcnt lgkmcnt(0)
    v_lshlrev_b32 v166, 16, v104
    v_and_b32 v167, 0xffff0000, v104
    v_lshlrev_b32 v168, 16, v105
    v_and_b32 v169, 0xffff0000, v105
    v_lshlrev_b32 v170, 16, v106
    v_and_b32 v171, 0xffff0000, v106
    v_lshlrev_b32 v172, 16, v107
    v_and_b32 v173, 0xffff0000, v107
    v_lshlrev_b32 v174, 16, v108
    v_and_b32 v175, 0xffff0000, v108
    v_lshlrev_b32 v176, 16, v109
    v_and_b32 v177, 0xffff0000, v109
    v_lshlrev_b32 v178, 16, v110
    v_and_b32 v179, 0xffff0000, v110
    v_lshlrev_b32 v180, 16, v111
    v_and_b32 v181, 0xffff0000, v111
    s_waitcnt lgkmcnt(0)
    v_mov_b32 v122, 158912
    v_mov_b32 v123, 1
    s_waitcnt vmcnt(0)
    s_nop 15
    s_setprio 2
    s_mov_b64 exec, 1
    ds_add_u32 v122, v123 offset:4
    s_mov_b64 exec, -1
    s_nop 15
    ds_read_b64_tr_b16 v[104:105], v101 offset:0
    ds_read_b64_tr_b16 v[106:107], v101 offset:128
    ds_read_b64_tr_b16 v[108:109], v101 offset:256
    ds_read_b64_tr_b16 v[110:111], v101 offset:384
    ds_read_b64_tr_b16 v[112:113], v101 offset:512
    ds_read_b64_tr_b16 v[114:115], v101 offset:640
    ds_read_b64_tr_b16 v[116:117], v101 offset:768
    ds_read_b64_tr_b16 v[152:153], v101 offset:1824
    ds_read_b64_tr_b16 v[154:155], v101 offset:1952
    ds_read_b64_tr_b16 v[156:157], v101 offset:2080
    ds_read_b64_tr_b16 v[158:159], v101 offset:2208
    ds_read_b64_tr_b16 v[160:161], v101 offset:2336
    ds_read_b64_tr_b16 v[162:163], v101 offset:2464
    ds_read_b64_tr_b16 v[164:165], v101 offset:2592
    s_waitcnt lgkmcnt(0)
    s_mov_b64 exec, 1
    ds_add_u32 v122, v123
    s_mov_b64 exec, -1
    ds_read_b128 v[82:85], v100 offset:0
    ds_read_b128 v[86:89], v100 offset:23744
    ds_read_b128 v[90:93], v100 offset:848
    ds_read_b128 v[94:97], v100 offset:24592
    v_lshlrev_b32 v2, 16, v104
    v_and_b32 v3, 0xffff0000, v104
    v_lshlrev_b32 v4, 16, v105
    v_and_b32 v5, 0xffff0000, v105
    v_lshlrev_b32 v6, 16, v106
    v_and_b32 v7, 0xffff0000, v106
    v_lshlrev_b32 v8, 16, v107
    v_and_b32 v9, 0xffff0000, v107
    v_lshlrev_b32 v10, 16, v108
    v_and_b32 v11, 0xffff0000, v108
    v_lshlrev_b32 v12, 16, v109
    v_and_b32 v13, 0xffff0000, v109
    v_lshlrev_b32 v14, 16, v110
    v_and_b32 v15, 0xffff0000, v110
    v_lshlrev_b32 v16, 16, v111
    v_and_b32 v17, 0xffff0000, v111
    v_lshlrev_b32 v18, 16, v112
    v_and_b32 v19, 0xffff0000, v112
    v_lshlrev_b32 v20, 16, v113
    v_and_b32 v21, 0xffff0000, v113
    v_lshlrev_b32 v22, 16, v114
    v_and_b32 v23, 0xffff0000, v114
    v_lshlrev_b32 v24, 16, v115
    v_and_b32 v25, 0xffff0000, v115
    v_lshlrev_b32 v26, 16, v116
    v_and_b32 v27, 0xffff0000, v116
    v_lshlrev_b32 v28, 16, v117
    v_and_b32 v29, 0xffff0000, v117
    v_mul_f32_e64 v74, v2, v2 div:2
    v_mul_f32_e64 v75, v2, v3 div:2
    v_mul_f32_e64 v76, v2, v4 div:2
    v_mul_f32_e64 v77, v2, v5 div:2
    v_cvt_pk_bf16_f32 v58, v74, v75
    v_cvt_pk_bf16_f32 v59, v76, v77
    v_mul_f32_e64 v78, v3, v2 div:2
    v_mul_f32_e64 v79, v3, v3 div:2
    v_mul_f32_e64 v80, v3, v4 div:2
    v_mul_f32_e64 v81, v3, v5 div:2
    v_cvt_pk_bf16_f32 v60, v78, v79
    v_cvt_pk_bf16_f32 v61, v80, v81
    v_lshlrev_b32 v30, 16, v152
    v_and_b32 v31, 0xffff0000, v152
    v_lshlrev_b32 v32, 16, v153
    v_and_b32 v33, 0xffff0000, v153
    v_lshlrev_b32 v34, 16, v154
    v_and_b32 v35, 0xffff0000, v154
    v_lshlrev_b32 v36, 16, v155
    v_and_b32 v37, 0xffff0000, v155
    v_lshlrev_b32 v38, 16, v156
    v_and_b32 v39, 0xffff0000, v156
    v_lshlrev_b32 v40, 16, v157
    v_and_b32 v41, 0xffff0000, v157
    v_lshlrev_b32 v42, 16, v158
    v_and_b32 v43, 0xffff0000, v158
    v_lshlrev_b32 v44, 16, v159
    v_and_b32 v45, 0xffff0000, v159
    v_lshlrev_b32 v46, 16, v160
    v_and_b32 v47, 0xffff0000, v160
    v_lshlrev_b32 v48, 16, v161
    v_and_b32 v49, 0xffff0000, v161
    v_lshlrev_b32 v50, 16, v162
    v_and_b32 v51, 0xffff0000, v162
    v_lshlrev_b32 v52, 16, v163
    v_and_b32 v53, 0xffff0000, v163
    v_lshlrev_b32 v54, 16, v164
    v_and_b32 v55, 0xffff0000, v164
    v_lshlrev_b32 v56, 16, v165
    v_and_b32 v57, 0xffff0000, v165
    v_mul_f32_e64 v74, v30, v30 div:2
    v_mul_f32_e64 v75, v30, v31 div:2
    v_mul_f32_e64 v76, v30, v32 div:2
    v_mul_f32_e64 v77, v30, v33 div:2
    v_cvt_pk_bf16_f32 v66, v74, v75
    v_cvt_pk_bf16_f32 v67, v76, v77
    v_mul_f32_e64 v78, v31, v30 div:2
    v_mul_f32_e64 v79, v31, v31 div:2
    v_mul_f32_e64 v80, v31, v32 div:2
    v_mul_f32_e64 v81, v31, v33 div:2
    v_cvt_pk_bf16_f32 v68, v78, v79
    v_cvt_pk_bf16_f32 v69, v80, v81
    s_waitcnt lgkmcnt(2)
    v_mfma_f32_32x32x16_bf16 v[192:207], v[82:85], v[58:61], 0
    v_mul_f32 v74, v2, v6
    v_mul_f32 v75, v2, v7
    v_mul_f32 v76, v2, v8
    v_mul_f32 v77, v2, v9
    v_cvt_pk_bf16_f32 v62, v74, v75
    v_cvt_pk_bf16_f32 v63, v76, v77
    v_mfma_f32_32x32x16_bf16 v[208:223], v[86:89], v[58:61], v[166:181]
    v_mul_f32 v78, v3, v6
    v_mul_f32 v79, v3, v7
    v_mul_f32 v80, v3, v8
    v_mul_f32 v81, v3, v9
    v_cvt_pk_bf16_f32 v64, v78, v79
    v_cvt_pk_bf16_f32 v65, v80, v81
    v_mfma_f32_32x32x16_bf16 v[224:239], v[82:85], v[66:69], 0
    v_mul_f32 v74, v30, v34
    v_mul_f32 v75, v30, v35
    v_mul_f32 v76, v30, v36
    v_mul_f32 v77, v30, v37
    v_cvt_pk_bf16_f32 v70, v74, v75
    v_cvt_pk_bf16_f32 v71, v76, v77
    v_mfma_f32_32x32x16_bf16 v[240:255], v[86:89], v[66:69], v[166:181]
    ds_read_b128 v[82:85], v100 offset:1696
    ds_read_b128 v[86:89], v100 offset:25440
    v_mul_f32 v78, v31, v34
    v_mul_f32 v79, v31, v35
    v_mul_f32 v80, v31, v36
    v_mul_f32 v81, v31, v37
    v_cvt_pk_bf16_f32 v72, v78, v79
    v_cvt_pk_bf16_f32 v73, v80, v81
    s_waitcnt lgkmcnt(2)
    v_mfma_f32_32x32x16_bf16 v[192:207], v[90:93], v[62:65], v[192:207]
    v_mul_f32_e64 v74, v6, v6 div:2
    v_mul_f32_e64 v75, v6, v7 div:2
    v_mul_f32_e64 v76, v6, v8 div:2
    v_mul_f32_e64 v77, v6, v9 div:2
    v_cvt_pk_bf16_f32 v58, v74, v75
    v_cvt_pk_bf16_f32 v59, v76, v77
    v_mfma_f32_32x32x16_bf16 v[208:223], v[94:97], v[62:65], v[208:223]
    v_mul_f32_e64 v78, v7, v6 div:2
    v_mul_f32_e64 v79, v7, v7 div:2
    v_mul_f32_e64 v80, v7, v8 div:2
    v_mul_f32_e64 v81, v7, v9 div:2
    v_cvt_pk_bf16_f32 v60, v78, v79
    v_cvt_pk_bf16_f32 v61, v80, v81
    s_setprio 0
    v_mfma_f32_32x32x16_bf16 v[224:239], v[90:93], v[70:73], v[224:239]
    v_mul_f32_e64 v74, v34, v34 div:2
    v_mul_f32_e64 v75, v34, v35 div:2
    v_mul_f32_e64 v76, v34, v36 div:2
    v_mul_f32_e64 v77, v34, v37 div:2
    v_cvt_pk_bf16_f32 v66, v74, v75
    v_cvt_pk_bf16_f32 v67, v76, v77
    v_mfma_f32_32x32x16_bf16 v[240:255], v[94:97], v[70:73], v[240:255]
    ds_read_b128 v[90:93], v100 offset:2544
    ds_read_b128 v[94:97], v100 offset:26288
    v_mul_f32_e64 v78, v35, v34 div:2
    v_mul_f32_e64 v79, v35, v35 div:2
    v_mul_f32_e64 v80, v35, v36 div:2
    v_mul_f32_e64 v81, v35, v37 div:2
    v_cvt_pk_bf16_f32 v68, v78, v79
    v_cvt_pk_bf16_f32 v69, v80, v81
    s_waitcnt lgkmcnt(2)
    v_mfma_f32_32x32x16_bf16 v[192:207], v[82:85], v[58:61], v[192:207]
    v_mul_f32 v74, v2, v10
    v_mul_f32 v75, v2, v11
    v_mul_f32 v76, v2, v12
    v_mul_f32 v77, v2, v13
    v_cvt_pk_bf16_f32 v62, v74, v75
    v_cvt_pk_bf16_f32 v63, v76, v77
    v_mfma_f32_32x32x16_bf16 v[208:223], v[86:89], v[58:61], v[208:223]
    v_mul_f32 v78, v3, v10
    v_mul_f32 v79, v3, v11
    v_mul_f32 v80, v3, v12
    v_mul_f32 v81, v3, v13
    v_cvt_pk_bf16_f32 v64, v78, v79
    v_cvt_pk_bf16_f32 v65, v80, v81
    v_mfma_f32_32x32x16_bf16 v[224:239], v[82:85], v[66:69], v[224:239]
    v_mul_f32 v74, v30, v38
    v_mul_f32 v75, v30, v39
    v_mul_f32 v76, v30, v40
    v_mul_f32 v77, v30, v41
    v_cvt_pk_bf16_f32 v70, v74, v75
    v_cvt_pk_bf16_f32 v71, v76, v77
    v_mfma_f32_32x32x16_bf16 v[240:255], v[86:89], v[66:69], v[240:255]
    ds_read_b128 v[82:85], v100 offset:3392
    ds_read_b128 v[86:89], v100 offset:27136
    v_mul_f32 v78, v31, v38
    v_mul_f32 v79, v31, v39
    v_mul_f32 v80, v31, v40
    v_mul_f32 v81, v31, v41
    v_cvt_pk_bf16_f32 v72, v78, v79
    v_cvt_pk_bf16_f32 v73, v80, v81
    s_waitcnt lgkmcnt(2)
    v_mfma_f32_32x32x16_bf16 v[192:207], v[90:93], v[62:65], v[192:207]
    v_mul_f32 v74, v6, v10
    v_mul_f32 v75, v6, v11
    v_mul_f32 v76, v6, v12
    v_mul_f32 v77, v6, v13
    v_cvt_pk_bf16_f32 v58, v74, v75
    v_cvt_pk_bf16_f32 v59, v76, v77
    v_mfma_f32_32x32x16_bf16 v[208:223], v[94:97], v[62:65], v[208:223]
    v_mul_f32 v78, v7, v10
    v_mul_f32 v79, v7, v11
    v_mul_f32 v80, v7, v12
    v_mul_f32 v81, v7, v13
    v_cvt_pk_bf16_f32 v60, v78, v79
    v_cvt_pk_bf16_f32 v61, v80, v81
    v_mfma_f32_32x32x16_bf16 v[224:239], v[90:93], v[70:73], v[224:239]
    v_mul_f32 v74, v34, v38
    v_mul_f32 v75, v34, v39
    v_mul_f32 v76, v34, v40
    v_mul_f32 v77, v34, v41
    v_cvt_pk_bf16_f32 v66, v74, v75
    v_cvt_pk_bf16_f32 v67, v76, v77
    v_mfma_f32_32x32x16_bf16 v[240:255], v[94:97], v[70:73], v[240:255]
    ds_read_b128 v[90:93], v100 offset:4240
    ds_read_b128 v[94:97], v100 offset:27984
    v_mul_f32 v78, v35, v38
    v_mul_f32 v79, v35, v39
    v_mul_f32 v80, v35, v40
    v_mul_f32 v81, v35, v41
    v_cvt_pk_bf16_f32 v68, v78, v79
    v_cvt_pk_bf16_f32 v69, v80, v81
    s_waitcnt lgkmcnt(2)
    v_mfma_f32_32x32x16_bf16 v[192:207], v[82:85], v[58:61], v[192:207]
    v_mul_f32_e64 v74, v10, v10 div:2
    v_mul_f32_e64 v75, v10, v11 div:2
    v_mul_f32_e64 v76, v10, v12 div:2
    v_mul_f32_e64 v77, v10, v13 div:2
    v_cvt_pk_bf16_f32 v62, v74, v75
    v_cvt_pk_bf16_f32 v63, v76, v77
    v_mfma_f32_32x32x16_bf16 v[208:223], v[86:89], v[58:61], v[208:223]
    v_mul_f32_e64 v78, v11, v10 div:2
    v_mul_f32_e64 v79, v11, v11 div:2
    v_mul_f32_e64 v80, v11, v12 div:2
    v_mul_f32_e64 v81, v11, v13 div:2
    v_cvt_pk_bf16_f32 v64, v78, v79
    v_cvt_pk_bf16_f32 v65, v80, v81
    v_mfma_f32_32x32x16_bf16 v[224:239], v[82:85], v[66:69], v[224:239]
    v_mul_f32_e64 v74, v38, v38 div:2
    v_mul_f32_e64 v75, v38, v39 div:2
    v_mul_f32_e64 v76, v38, v40 div:2
    v_mul_f32_e64 v77, v38, v41 div:2
    v_cvt_pk_bf16_f32 v70, v74, v75
    v_cvt_pk_bf16_f32 v71, v76, v77
    v_mfma_f32_32x32x16_bf16 v[240:255], v[86:89], v[66:69], v[240:255]
    ds_read_b128 v[82:85], v100 offset:5088
    ds_read_b128 v[86:89], v100 offset:28832
    v_mul_f32_e64 v78, v39, v38 div:2
    v_mul_f32_e64 v79, v39, v39 div:2
    v_mul_f32_e64 v80, v39, v40 div:2
    v_mul_f32_e64 v81, v39, v41 div:2
    v_cvt_pk_bf16_f32 v72, v78, v79
    v_cvt_pk_bf16_f32 v73, v80, v81
    s_waitcnt lgkmcnt(2)
    v_mfma_f32_32x32x16_bf16 v[192:207], v[90:93], v[62:65], v[192:207]
    v_mul_f32 v74, v2, v14
    v_mul_f32 v75, v2, v15
    v_mul_f32 v76, v2, v16
    v_mul_f32 v77, v2, v17
    v_cvt_pk_bf16_f32 v58, v74, v75
    v_cvt_pk_bf16_f32 v59, v76, v77
    v_mfma_f32_32x32x16_bf16 v[208:223], v[94:97], v[62:65], v[208:223]
    v_mul_f32 v78, v3, v14
    v_mul_f32 v79, v3, v15
    v_mul_f32 v80, v3, v16
    v_mul_f32 v81, v3, v17
    v_cvt_pk_bf16_f32 v60, v78, v79
    v_cvt_pk_bf16_f32 v61, v80, v81
    v_mfma_f32_32x32x16_bf16 v[224:239], v[90:93], v[70:73], v[224:239]
    v_mul_f32 v74, v30, v42
    v_mul_f32 v75, v30, v43
    v_mul_f32 v76, v30, v44
    v_mul_f32 v77, v30, v45
    v_cvt_pk_bf16_f32 v66, v74, v75
    v_cvt_pk_bf16_f32 v67, v76, v77
    v_mfma_f32_32x32x16_bf16 v[240:255], v[94:97], v[70:73], v[240:255]
    ds_read_b128 v[90:93], v100 offset:5936
    ds_read_b128 v[94:97], v100 offset:29680
    v_mul_f32 v78, v31, v42
    v_mul_f32 v79, v31, v43
    v_mul_f32 v80, v31, v44
    v_mul_f32 v81, v31, v45
    v_cvt_pk_bf16_f32 v68, v78, v79
    v_cvt_pk_bf16_f32 v69, v80, v81
    s_waitcnt lgkmcnt(2)
    v_mfma_f32_32x32x16_bf16 v[192:207], v[82:85], v[58:61], v[192:207]
    v_mul_f32 v74, v6, v14
    v_mul_f32 v75, v6, v15
    v_mul_f32 v76, v6, v16
    v_mul_f32 v77, v6, v17
    v_cvt_pk_bf16_f32 v62, v74, v75
    v_cvt_pk_bf16_f32 v63, v76, v77
    v_mfma_f32_32x32x16_bf16 v[208:223], v[86:89], v[58:61], v[208:223]
    v_mul_f32 v78, v7, v14
    v_mul_f32 v79, v7, v15
    v_mul_f32 v80, v7, v16
    v_mul_f32 v81, v7, v17
    v_cvt_pk_bf16_f32 v64, v78, v79
    v_cvt_pk_bf16_f32 v65, v80, v81
    v_mfma_f32_32x32x16_bf16 v[224:239], v[82:85], v[66:69], v[224:239]
    v_mul_f32 v74, v34, v42
    v_mul_f32 v75, v34, v43
    v_mul_f32 v76, v34, v44
    v_mul_f32 v77, v34, v45
    v_cvt_pk_bf16_f32 v70, v74, v75
    v_cvt_pk_bf16_f32 v71, v76, v77
    v_mfma_f32_32x32x16_bf16 v[240:255], v[86:89], v[66:69], v[240:255]
    ds_read_b128 v[82:85], v100 offset:6784
    ds_read_b128 v[86:89], v100 offset:30528
    v_mul_f32 v78, v35, v42
    v_mul_f32 v79, v35, v43
    v_mul_f32 v80, v35, v44
    v_mul_f32 v81, v35, v45
    v_cvt_pk_bf16_f32 v72, v78, v79
    v_cvt_pk_bf16_f32 v73, v80, v81
    s_waitcnt lgkmcnt(2)
    v_mfma_f32_32x32x16_bf16 v[192:207], v[90:93], v[62:65], v[192:207]
    v_mul_f32 v74, v10, v14
    v_mul_f32 v75, v10, v15
    v_mul_f32 v76, v10, v16
    v_mul_f32 v77, v10, v17
    v_cvt_pk_bf16_f32 v58, v74, v75
    v_cvt_pk_bf16_f32 v59, v76, v77
    v_mfma_f32_32x32x16_bf16 v[208:223], v[94:97], v[62:65], v[208:223]
    v_mul_f32 v78, v11, v14
    v_mul_f32 v79, v11, v15
    v_mul_f32 v80, v11, v16
    v_mul_f32 v81, v11, v17
    v_cvt_pk_bf16_f32 v60, v78, v79
    v_cvt_pk_bf16_f32 v61, v80, v81
    v_mfma_f32_32x32x16_bf16 v[224:239], v[90:93], v[70:73], v[224:239]
    v_mul_f32 v74, v38, v42
    v_mul_f32 v75, v38, v43
    v_mul_f32 v76, v38, v44
    v_mul_f32 v77, v38, v45
    v_cvt_pk_bf16_f32 v66, v74, v75
    v_cvt_pk_bf16_f32 v67, v76, v77
    v_mfma_f32_32x32x16_bf16 v[240:255], v[94:97], v[70:73], v[240:255]
    ds_read_b128 v[90:93], v100 offset:7632
    ds_read_b128 v[94:97], v100 offset:31376
    v_mul_f32 v78, v39, v42
    v_mul_f32 v79, v39, v43
    v_mul_f32 v80, v39, v44
    v_mul_f32 v81, v39, v45
    v_cvt_pk_bf16_f32 v68, v78, v79
    v_cvt_pk_bf16_f32 v69, v80, v81
    s_waitcnt lgkmcnt(2)
    v_mfma_f32_32x32x16_bf16 v[192:207], v[82:85], v[58:61], v[192:207]
    v_mul_f32_e64 v74, v14, v14 div:2
    v_mul_f32_e64 v75, v14, v15 div:2
    v_mul_f32_e64 v76, v14, v16 div:2
    v_mul_f32_e64 v77, v14, v17 div:2
    v_cvt_pk_bf16_f32 v62, v74, v75
    v_cvt_pk_bf16_f32 v63, v76, v77
    v_mfma_f32_32x32x16_bf16 v[208:223], v[86:89], v[58:61], v[208:223]
    v_mul_f32_e64 v78, v15, v14 div:2
    v_mul_f32_e64 v79, v15, v15 div:2
    v_mul_f32_e64 v80, v15, v16 div:2
    v_mul_f32_e64 v81, v15, v17 div:2
    v_cvt_pk_bf16_f32 v64, v78, v79
    v_cvt_pk_bf16_f32 v65, v80, v81
    v_mfma_f32_32x32x16_bf16 v[224:239], v[82:85], v[66:69], v[224:239]
    v_mul_f32_e64 v74, v42, v42 div:2
    v_mul_f32_e64 v75, v42, v43 div:2
    v_mul_f32_e64 v76, v42, v44 div:2
    v_mul_f32_e64 v77, v42, v45 div:2
    v_cvt_pk_bf16_f32 v70, v74, v75
    v_cvt_pk_bf16_f32 v71, v76, v77
    v_mfma_f32_32x32x16_bf16 v[240:255], v[86:89], v[66:69], v[240:255]
    ds_read_b128 v[82:85], v100 offset:8480
    ds_read_b128 v[86:89], v100 offset:32224
    v_mul_f32_e64 v78, v43, v42 div:2
    v_mul_f32_e64 v79, v43, v43 div:2
    v_mul_f32_e64 v80, v43, v44 div:2
    v_mul_f32_e64 v81, v43, v45 div:2
    v_cvt_pk_bf16_f32 v72, v78, v79
    v_cvt_pk_bf16_f32 v73, v80, v81
    s_waitcnt lgkmcnt(2)
    v_mfma_f32_32x32x16_bf16 v[192:207], v[90:93], v[62:65], v[192:207]
    v_mul_f32 v74, v2, v18
    v_mul_f32 v75, v2, v19
    v_mul_f32 v76, v2, v20
    v_mul_f32 v77, v2, v21
    v_cvt_pk_bf16_f32 v58, v74, v75
    v_cvt_pk_bf16_f32 v59, v76, v77
    v_mfma_f32_32x32x16_bf16 v[208:223], v[94:97], v[62:65], v[208:223]
    v_mul_f32 v78, v3, v18
    v_mul_f32 v79, v3, v19
    v_mul_f32 v80, v3, v20
    v_mul_f32 v81, v3, v21
    v_cvt_pk_bf16_f32 v60, v78, v79
    v_cvt_pk_bf16_f32 v61, v80, v81
    v_mfma_f32_32x32x16_bf16 v[224:239], v[90:93], v[70:73], v[224:239]
    v_mul_f32 v74, v30, v46
    v_mul_f32 v75, v30, v47
    v_mul_f32 v76, v30, v48
    v_mul_f32 v77, v30, v49
    v_cvt_pk_bf16_f32 v66, v74, v75
    v_cvt_pk_bf16_f32 v67, v76, v77
    v_mfma_f32_32x32x16_bf16 v[240:255], v[94:97], v[70:73], v[240:255]
    ds_read_b128 v[90:93], v100 offset:9328
    ds_read_b128 v[94:97], v100 offset:33072
    v_mul_f32 v78, v31, v46
    v_mul_f32 v79, v31, v47
    v_mul_f32 v80, v31, v48
    v_mul_f32 v81, v31, v49
    v_cvt_pk_bf16_f32 v68, v78, v79
    v_cvt_pk_bf16_f32 v69, v80, v81
    s_waitcnt lgkmcnt(2)
    v_mfma_f32_32x32x16_bf16 v[192:207], v[82:85], v[58:61], v[192:207]
    v_mul_f32 v74, v6, v18
    v_mul_f32 v75, v6, v19
    v_mul_f32 v76, v6, v20
    v_mul_f32 v77, v6, v21
    v_cvt_pk_bf16_f32 v62, v74, v75
    v_cvt_pk_bf16_f32 v63, v76, v77
    v_mfma_f32_32x32x16_bf16 v[208:223], v[86:89], v[58:61], v[208:223]
    v_mul_f32 v78, v7, v18
    v_mul_f32 v79, v7, v19
    v_mul_f32 v80, v7, v20
    v_mul_f32 v81, v7, v21
    v_cvt_pk_bf16_f32 v64, v78, v79
    v_cvt_pk_bf16_f32 v65, v80, v81
    v_mfma_f32_32x32x16_bf16 v[224:239], v[82:85], v[66:69], v[224:239]
    v_mul_f32 v74, v34, v46
    v_mul_f32 v75, v34, v47
    v_mul_f32 v76, v34, v48
    v_mul_f32 v77, v34, v49
    v_cvt_pk_bf16_f32 v70, v74, v75
    v_cvt_pk_bf16_f32 v71, v76, v77
    v_mfma_f32_32x32x16_bf16 v[240:255], v[86:89], v[66:69], v[240:255]
    ds_read_b128 v[82:85], v100 offset:10176
    ds_read_b128 v[86:89], v100 offset:33920
    v_mul_f32 v78, v35, v46
    v_mul_f32 v79, v35, v47
    v_mul_f32 v80, v35, v48
    v_mul_f32 v81, v35, v49
    v_cvt_pk_bf16_f32 v72, v78, v79
    v_cvt_pk_bf16_f32 v73, v80, v81
    s_waitcnt lgkmcnt(2)
    v_mfma_f32_32x32x16_bf16 v[192:207], v[90:93], v[62:65], v[192:207]
    v_mul_f32 v74, v10, v18
    v_mul_f32 v75, v10, v19
    v_mul_f32 v76, v10, v20
    v_mul_f32 v77, v10, v21
    v_cvt_pk_bf16_f32 v58, v74, v75
    v_cvt_pk_bf16_f32 v59, v76, v77
    v_mfma_f32_32x32x16_bf16 v[208:223], v[94:97], v[62:65], v[208:223]
    v_mul_f32 v78, v11, v18
    v_mul_f32 v79, v11, v19
    v_mul_f32 v80, v11, v20
    v_mul_f32 v81, v11, v21
    v_cvt_pk_bf16_f32 v60, v78, v79
    v_cvt_pk_bf16_f32 v61, v80, v81
    v_mfma_f32_32x32x16_bf16 v[224:239], v[90:93], v[70:73], v[224:239]
    v_mul_f32 v74, v38, v46
    v_mul_f32 v75, v38, v47
    v_mul_f32 v76, v38, v48
    v_mul_f32 v77, v38, v49
    v_cvt_pk_bf16_f32 v66, v74, v75
    v_cvt_pk_bf16_f32 v67, v76, v77
    v_mfma_f32_32x32x16_bf16 v[240:255], v[94:97], v[70:73], v[240:255]
    ds_read_b128 v[90:93], v100 offset:11024
    ds_read_b128 v[94:97], v100 offset:34768
    v_mul_f32 v78, v39, v46
    v_mul_f32 v79, v39, v47
    v_mul_f32 v80, v39, v48
    v_mul_f32 v81, v39, v49
    v_cvt_pk_bf16_f32 v68, v78, v79
    v_cvt_pk_bf16_f32 v69, v80, v81
    s_waitcnt lgkmcnt(2)
    v_mfma_f32_32x32x16_bf16 v[192:207], v[82:85], v[58:61], v[192:207]
    v_mul_f32 v74, v14, v18
    v_mul_f32 v75, v14, v19
    v_mul_f32 v76, v14, v20
    v_mul_f32 v77, v14, v21
    v_cvt_pk_bf16_f32 v62, v74, v75
    v_cvt_pk_bf16_f32 v63, v76, v77
    v_mfma_f32_32x32x16_bf16 v[208:223], v[86:89], v[58:61], v[208:223]
    v_mul_f32 v78, v15, v18
    v_mul_f32 v79, v15, v19
    v_mul_f32 v80, v15, v20
    v_mul_f32 v81, v15, v21
    v_cvt_pk_bf16_f32 v64, v78, v79
    v_cvt_pk_bf16_f32 v65, v80, v81
    v_mfma_f32_32x32x16_bf16 v[224:239], v[82:85], v[66:69], v[224:239]
    v_mul_f32 v74, v42, v46
    v_mul_f32 v75, v42, v47
    v_mul_f32 v76, v42, v48
    v_mul_f32 v77, v42, v49
    v_cvt_pk_bf16_f32 v70, v74, v75
    v_cvt_pk_bf16_f32 v71, v76, v77
    v_mfma_f32_32x32x16_bf16 v[240:255], v[86:89], v[66:69], v[240:255]
    ds_read_b128 v[82:85], v100 offset:11872
    ds_read_b128 v[86:89], v100 offset:35616
    v_mul_f32 v78, v43, v46
    v_mul_f32 v79, v43, v47
    v_mul_f32 v80, v43, v48
    v_mul_f32 v81, v43, v49
    v_cvt_pk_bf16_f32 v72, v78, v79
    v_cvt_pk_bf16_f32 v73, v80, v81
    s_waitcnt lgkmcnt(2)
    v_mfma_f32_32x32x16_bf16 v[192:207], v[90:93], v[62:65], v[192:207]
    v_mul_f32_e64 v74, v18, v18 div:2
    v_mul_f32_e64 v75, v18, v19 div:2
    v_mul_f32_e64 v76, v18, v20 div:2
    v_mul_f32_e64 v77, v18, v21 div:2
    v_cvt_pk_bf16_f32 v58, v74, v75
    v_cvt_pk_bf16_f32 v59, v76, v77
    v_mfma_f32_32x32x16_bf16 v[208:223], v[94:97], v[62:65], v[208:223]
    v_mul_f32_e64 v78, v19, v18 div:2
    v_mul_f32_e64 v79, v19, v19 div:2
    v_mul_f32_e64 v80, v19, v20 div:2
    v_mul_f32_e64 v81, v19, v21 div:2
    v_cvt_pk_bf16_f32 v60, v78, v79
    v_cvt_pk_bf16_f32 v61, v80, v81
    v_mfma_f32_32x32x16_bf16 v[224:239], v[90:93], v[70:73], v[224:239]
    v_mul_f32_e64 v74, v46, v46 div:2
    v_mul_f32_e64 v75, v46, v47 div:2
    v_mul_f32_e64 v76, v46, v48 div:2
    v_mul_f32_e64 v77, v46, v49 div:2
    v_cvt_pk_bf16_f32 v66, v74, v75
    v_cvt_pk_bf16_f32 v67, v76, v77
    v_mfma_f32_32x32x16_bf16 v[240:255], v[94:97], v[70:73], v[240:255]
    ds_read_b128 v[90:93], v100 offset:12720
    ds_read_b128 v[94:97], v100 offset:36464
    v_mul_f32_e64 v78, v47, v46 div:2
    v_mul_f32_e64 v79, v47, v47 div:2
    v_mul_f32_e64 v80, v47, v48 div:2
    v_mul_f32_e64 v81, v47, v49 div:2
    v_cvt_pk_bf16_f32 v68, v78, v79
    v_cvt_pk_bf16_f32 v69, v80, v81
    s_waitcnt lgkmcnt(2)
    v_mfma_f32_32x32x16_bf16 v[192:207], v[82:85], v[58:61], v[192:207]
    v_mul_f32 v74, v2, v22
    v_mul_f32 v75, v2, v23
    v_mul_f32 v76, v2, v24
    v_mul_f32 v77, v2, v25
    v_cvt_pk_bf16_f32 v62, v74, v75
    v_cvt_pk_bf16_f32 v63, v76, v77
    v_mfma_f32_32x32x16_bf16 v[208:223], v[86:89], v[58:61], v[208:223]
    v_mul_f32 v78, v3, v22
    v_mul_f32 v79, v3, v23
    v_mul_f32 v80, v3, v24
    v_mul_f32 v81, v3, v25
    v_cvt_pk_bf16_f32 v64, v78, v79
    v_cvt_pk_bf16_f32 v65, v80, v81
    v_mfma_f32_32x32x16_bf16 v[224:239], v[82:85], v[66:69], v[224:239]
    v_mul_f32 v74, v30, v50
    v_mul_f32 v75, v30, v51
    v_mul_f32 v76, v30, v52
    v_mul_f32 v77, v30, v53
    v_cvt_pk_bf16_f32 v70, v74, v75
    v_cvt_pk_bf16_f32 v71, v76, v77
    v_mfma_f32_32x32x16_bf16 v[240:255], v[86:89], v[66:69], v[240:255]
    ds_read_b128 v[82:85], v100 offset:13568
    ds_read_b128 v[86:89], v100 offset:37312
    v_mul_f32 v78, v31, v50
    v_mul_f32 v79, v31, v51
    v_mul_f32 v80, v31, v52
    v_mul_f32 v81, v31, v53
    v_cvt_pk_bf16_f32 v72, v78, v79
    v_cvt_pk_bf16_f32 v73, v80, v81
    s_waitcnt lgkmcnt(2)
    v_mfma_f32_32x32x16_bf16 v[192:207], v[90:93], v[62:65], v[192:207]
    v_mul_f32 v74, v6, v22
    v_mul_f32 v75, v6, v23
    v_mul_f32 v76, v6, v24
    v_mul_f32 v77, v6, v25
    v_cvt_pk_bf16_f32 v58, v74, v75
    v_cvt_pk_bf16_f32 v59, v76, v77
    v_mfma_f32_32x32x16_bf16 v[208:223], v[94:97], v[62:65], v[208:223]
    v_mul_f32 v78, v7, v22
    v_mul_f32 v79, v7, v23
    v_mul_f32 v80, v7, v24
    v_mul_f32 v81, v7, v25
    v_cvt_pk_bf16_f32 v60, v78, v79
    v_cvt_pk_bf16_f32 v61, v80, v81
    v_mfma_f32_32x32x16_bf16 v[224:239], v[90:93], v[70:73], v[224:239]
    v_mul_f32 v74, v34, v50
    v_mul_f32 v75, v34, v51
    v_mul_f32 v76, v34, v52
    v_mul_f32 v77, v34, v53
    v_cvt_pk_bf16_f32 v66, v74, v75
    v_cvt_pk_bf16_f32 v67, v76, v77
    v_mfma_f32_32x32x16_bf16 v[240:255], v[94:97], v[70:73], v[240:255]
    ds_read_b128 v[90:93], v100 offset:14416
    ds_read_b128 v[94:97], v100 offset:38160
    v_mul_f32 v78, v35, v50
    v_mul_f32 v79, v35, v51
    v_mul_f32 v80, v35, v52
    v_mul_f32 v81, v35, v53
    v_cvt_pk_bf16_f32 v68, v78, v79
    v_cvt_pk_bf16_f32 v69, v80, v81
    s_waitcnt lgkmcnt(2)
    v_mfma_f32_32x32x16_bf16 v[192:207], v[82:85], v[58:61], v[192:207]
    v_mul_f32 v74, v10, v22
    v_mul_f32 v75, v10, v23
    v_mul_f32 v76, v10, v24
    v_mul_f32 v77, v10, v25
    v_cvt_pk_bf16_f32 v62, v74, v75
    v_cvt_pk_bf16_f32 v63, v76, v77
    v_mfma_f32_32x32x16_bf16 v[208:223], v[86:89], v[58:61], v[208:223]
    v_mul_f32 v78, v11, v22
    v_mul_f32 v79, v11, v23
    v_mul_f32 v80, v11, v24
    v_mul_f32 v81, v11, v25
    v_cvt_pk_bf16_f32 v64, v78, v79
    v_cvt_pk_bf16_f32 v65, v80, v81
    v_mfma_f32_32x32x16_bf16 v[224:239], v[82:85], v[66:69], v[224:239]
    v_mul_f32 v74, v38, v50
    v_mul_f32 v75, v38, v51
    v_mul_f32 v76, v38, v52
    v_mul_f32 v77, v38, v53
    v_cvt_pk_bf16_f32 v70, v74, v75
    v_cvt_pk_bf16_f32 v71, v76, v77
    v_mfma_f32_32x32x16_bf16 v[240:255], v[86:89], v[66:69], v[240:255]
    ds_read_b128 v[82:85], v100 offset:15264
    ds_read_b128 v[86:89], v100 offset:39008
    v_mul_f32 v78, v39, v50
    v_mul_f32 v79, v39, v51
    v_mul_f32 v80, v39, v52
    v_mul_f32 v81, v39, v53
    v_cvt_pk_bf16_f32 v72, v78, v79
    v_cvt_pk_bf16_f32 v73, v80, v81
    s_waitcnt lgkmcnt(2)
    v_mfma_f32_32x32x16_bf16 v[192:207], v[90:93], v[62:65], v[192:207]
    v_mul_f32 v74, v14, v22
    v_mul_f32 v75, v14, v23
    v_mul_f32 v76, v14, v24
    v_mul_f32 v77, v14, v25
    v_cvt_pk_bf16_f32 v58, v74, v75
    v_cvt_pk_bf16_f32 v59, v76, v77
    v_mfma_f32_32x32x16_bf16 v[208:223], v[94:97], v[62:65], v[208:223]
    v_mul_f32 v78, v15, v22
    v_mul_f32 v79, v15, v23
    v_mul_f32 v80, v15, v24
    v_mul_f32 v81, v15, v25
    v_cvt_pk_bf16_f32 v60, v78, v79
    v_cvt_pk_bf16_f32 v61, v80, v81
    v_mfma_f32_32x32x16_bf16 v[224:239], v[90:93], v[70:73], v[224:239]
    v_mul_f32 v74, v42, v50
    v_mul_f32 v75, v42, v51
    v_mul_f32 v76, v42, v52
    v_mul_f32 v77, v42, v53
    v_cvt_pk_bf16_f32 v66, v74, v75
    v_cvt_pk_bf16_f32 v67, v76, v77
    v_mfma_f32_32x32x16_bf16 v[240:255], v[94:97], v[70:73], v[240:255]
    ds_read_b128 v[90:93], v100 offset:16112
    ds_read_b128 v[94:97], v100 offset:39856
    v_mul_f32 v78, v43, v50
    v_mul_f32 v79, v43, v51
    v_mul_f32 v80, v43, v52
    v_mul_f32 v81, v43, v53
    v_cvt_pk_bf16_f32 v68, v78, v79
    v_cvt_pk_bf16_f32 v69, v80, v81
    s_waitcnt lgkmcnt(2)
    v_mfma_f32_32x32x16_bf16 v[192:207], v[82:85], v[58:61], v[192:207]
    v_mul_f32 v74, v18, v22
    v_mul_f32 v75, v18, v23
    v_mul_f32 v76, v18, v24
    v_mul_f32 v77, v18, v25
    v_cvt_pk_bf16_f32 v62, v74, v75
    v_cvt_pk_bf16_f32 v63, v76, v77
    v_mfma_f32_32x32x16_bf16 v[208:223], v[86:89], v[58:61], v[208:223]
    v_mul_f32 v78, v19, v22
    v_mul_f32 v79, v19, v23
    v_mul_f32 v80, v19, v24
    v_mul_f32 v81, v19, v25
    v_cvt_pk_bf16_f32 v64, v78, v79
    v_cvt_pk_bf16_f32 v65, v80, v81
    v_mfma_f32_32x32x16_bf16 v[224:239], v[82:85], v[66:69], v[224:239]
    v_mul_f32 v74, v46, v50
    v_mul_f32 v75, v46, v51
    v_mul_f32 v76, v46, v52
    v_mul_f32 v77, v46, v53
    v_cvt_pk_bf16_f32 v70, v74, v75
    v_cvt_pk_bf16_f32 v71, v76, v77
    v_mfma_f32_32x32x16_bf16 v[240:255], v[86:89], v[66:69], v[240:255]
    ds_read_b128 v[82:85], v100 offset:16960
    ds_read_b128 v[86:89], v100 offset:40704
    v_mul_f32 v78, v47, v50
    v_mul_f32 v79, v47, v51
    v_mul_f32 v80, v47, v52
    v_mul_f32 v81, v47, v53
    v_cvt_pk_bf16_f32 v72, v78, v79
    v_cvt_pk_bf16_f32 v73, v80, v81
    s_waitcnt lgkmcnt(2)
    v_mfma_f32_32x32x16_bf16 v[192:207], v[90:93], v[62:65], v[192:207]
    v_mul_f32_e64 v74, v22, v22 div:2
    v_mul_f32_e64 v75, v22, v23 div:2
    v_mul_f32_e64 v76, v22, v24 div:2
    v_mul_f32_e64 v77, v22, v25 div:2
    v_cvt_pk_bf16_f32 v58, v74, v75
    v_cvt_pk_bf16_f32 v59, v76, v77
    v_mfma_f32_32x32x16_bf16 v[208:223], v[94:97], v[62:65], v[208:223]
    v_mul_f32_e64 v78, v23, v22 div:2
    v_mul_f32_e64 v79, v23, v23 div:2
    v_mul_f32_e64 v80, v23, v24 div:2
    v_mul_f32_e64 v81, v23, v25 div:2
    v_cvt_pk_bf16_f32 v60, v78, v79
    v_cvt_pk_bf16_f32 v61, v80, v81
    v_mfma_f32_32x32x16_bf16 v[224:239], v[90:93], v[70:73], v[224:239]
    v_mul_f32_e64 v74, v50, v50 div:2
    v_mul_f32_e64 v75, v50, v51 div:2
    v_mul_f32_e64 v76, v50, v52 div:2
    v_mul_f32_e64 v77, v50, v53 div:2
    v_cvt_pk_bf16_f32 v66, v74, v75
    v_cvt_pk_bf16_f32 v67, v76, v77
    v_mfma_f32_32x32x16_bf16 v[240:255], v[94:97], v[70:73], v[240:255]
    ds_read_b128 v[90:93], v100 offset:17808
    ds_read_b128 v[94:97], v100 offset:41552
    v_mul_f32_e64 v78, v51, v50 div:2
    v_mul_f32_e64 v79, v51, v51 div:2
    v_mul_f32_e64 v80, v51, v52 div:2
    v_mul_f32_e64 v81, v51, v53 div:2
    v_cvt_pk_bf16_f32 v68, v78, v79
    v_cvt_pk_bf16_f32 v69, v80, v81
    s_waitcnt lgkmcnt(2)
    v_mfma_f32_32x32x16_bf16 v[192:207], v[82:85], v[58:61], v[192:207]
    v_mul_f32 v74, v2, v26
    v_mul_f32 v75, v2, v27
    v_mul_f32 v76, v2, v28
    v_mul_f32 v77, v2, v29
    v_cvt_pk_bf16_f32 v62, v74, v75
    v_cvt_pk_bf16_f32 v63, v76, v77
    v_mfma_f32_32x32x16_bf16 v[208:223], v[86:89], v[58:61], v[208:223]
    v_mul_f32 v78, v3, v26
    v_mul_f32 v79, v3, v27
    v_mul_f32 v80, v3, v28
    v_mul_f32 v81, v3, v29
    v_cvt_pk_bf16_f32 v64, v78, v79
    v_cvt_pk_bf16_f32 v65, v80, v81
    v_mfma_f32_32x32x16_bf16 v[224:239], v[82:85], v[66:69], v[224:239]
    v_mul_f32 v74, v30, v54
    v_mul_f32 v75, v30, v55
    v_mul_f32 v76, v30, v56
    v_mul_f32 v77, v30, v57
    v_cvt_pk_bf16_f32 v70, v74, v75
    v_cvt_pk_bf16_f32 v71, v76, v77
    v_mfma_f32_32x32x16_bf16 v[240:255], v[86:89], v[66:69], v[240:255]
    ds_read_b128 v[82:85], v100 offset:18656
    ds_read_b128 v[86:89], v100 offset:42400
    v_mul_f32 v78, v31, v54
    v_mul_f32 v79, v31, v55
    v_mul_f32 v80, v31, v56
    v_mul_f32 v81, v31, v57
    v_cvt_pk_bf16_f32 v72, v78, v79
    v_cvt_pk_bf16_f32 v73, v80, v81
    s_waitcnt lgkmcnt(2)
    v_mfma_f32_32x32x16_bf16 v[192:207], v[90:93], v[62:65], v[192:207]
    v_mul_f32 v74, v6, v26
    v_mul_f32 v75, v6, v27
    v_mul_f32 v76, v6, v28
    v_mul_f32 v77, v6, v29
    v_cvt_pk_bf16_f32 v58, v74, v75
    v_cvt_pk_bf16_f32 v59, v76, v77
    v_mfma_f32_32x32x16_bf16 v[208:223], v[94:97], v[62:65], v[208:223]
    v_mul_f32 v78, v7, v26
    v_mul_f32 v79, v7, v27
    v_mul_f32 v80, v7, v28
    v_mul_f32 v81, v7, v29
    v_cvt_pk_bf16_f32 v60, v78, v79
    v_cvt_pk_bf16_f32 v61, v80, v81
    v_mfma_f32_32x32x16_bf16 v[224:239], v[90:93], v[70:73], v[224:239]
    v_mul_f32 v74, v34, v54
    v_mul_f32 v75, v34, v55
    v_mul_f32 v76, v34, v56
    v_mul_f32 v77, v34, v57
    v_cvt_pk_bf16_f32 v66, v74, v75
    v_cvt_pk_bf16_f32 v67, v76, v77
    v_mfma_f32_32x32x16_bf16 v[240:255], v[94:97], v[70:73], v[240:255]
    ds_read_b128 v[90:93], v100 offset:19504
    ds_read_b128 v[94:97], v100 offset:43248
    v_mul_f32 v78, v35, v54
    v_mul_f32 v79, v35, v55
    v_mul_f32 v80, v35, v56
    v_mul_f32 v81, v35, v57
    v_cvt_pk_bf16_f32 v68, v78, v79
    v_cvt_pk_bf16_f32 v69, v80, v81
    s_waitcnt lgkmcnt(2)
    v_mfma_f32_32x32x16_bf16 v[192:207], v[82:85], v[58:61], v[192:207]
    v_mul_f32 v74, v10, v26
    v_mul_f32 v75, v10, v27
    v_mul_f32 v76, v10, v28
    v_mul_f32 v77, v10, v29
    v_cvt_pk_bf16_f32 v62, v74, v75
    v_cvt_pk_bf16_f32 v63, v76, v77
    v_mfma_f32_32x32x16_bf16 v[208:223], v[86:89], v[58:61], v[208:223]
    v_mul_f32 v78, v11, v26
    v_mul_f32 v79, v11, v27
    v_mul_f32 v80, v11, v28
    v_mul_f32 v81, v11, v29
    v_cvt_pk_bf16_f32 v64, v78, v79
    v_cvt_pk_bf16_f32 v65, v80, v81
    v_mfma_f32_32x32x16_bf16 v[224:239], v[82:85], v[66:69], v[224:239]
    v_mul_f32 v74, v38, v54
    v_mul_f32 v75, v38, v55
    v_mul_f32 v76, v38, v56
    v_mul_f32 v77, v38, v57
    v_cvt_pk_bf16_f32 v70, v74, v75
    v_cvt_pk_bf16_f32 v71, v76, v77
    v_mfma_f32_32x32x16_bf16 v[240:255], v[86:89], v[66:69], v[240:255]
    ds_read_b128 v[82:85], v100 offset:20352
    ds_read_b128 v[86:89], v100 offset:44096
    v_mul_f32 v78, v39, v54
    v_mul_f32 v79, v39, v55
    v_mul_f32 v80, v39, v56
    v_mul_f32 v81, v39, v57
    v_cvt_pk_bf16_f32 v72, v78, v79
    v_cvt_pk_bf16_f32 v73, v80, v81
    s_waitcnt lgkmcnt(2)
    v_mfma_f32_32x32x16_bf16 v[192:207], v[90:93], v[62:65], v[192:207]
    v_mul_f32 v74, v14, v26
    v_mul_f32 v75, v14, v27
    v_mul_f32 v76, v14, v28
    v_mul_f32 v77, v14, v29
    v_cvt_pk_bf16_f32 v58, v74, v75
    v_cvt_pk_bf16_f32 v59, v76, v77
    v_mfma_f32_32x32x16_bf16 v[208:223], v[94:97], v[62:65], v[208:223]
    v_mul_f32 v78, v15, v26
    v_mul_f32 v79, v15, v27
    v_mul_f32 v80, v15, v28
    v_mul_f32 v81, v15, v29
    v_cvt_pk_bf16_f32 v60, v78, v79
    v_cvt_pk_bf16_f32 v61, v80, v81
    v_mfma_f32_32x32x16_bf16 v[224:239], v[90:93], v[70:73], v[224:239]
    v_mul_f32 v74, v42, v54
    v_mul_f32 v75, v42, v55
    v_mul_f32 v76, v42, v56
    v_mul_f32 v77, v42, v57
    v_cvt_pk_bf16_f32 v66, v74, v75
    v_cvt_pk_bf16_f32 v67, v76, v77
    v_mfma_f32_32x32x16_bf16 v[240:255], v[94:97], v[70:73], v[240:255]
    ds_read_b128 v[90:93], v100 offset:21200
    ds_read_b128 v[94:97], v100 offset:44944
    v_mul_f32 v78, v43, v54
    v_mul_f32 v79, v43, v55
    v_mul_f32 v80, v43, v56
    v_mul_f32 v81, v43, v57
    v_cvt_pk_bf16_f32 v68, v78, v79
    v_cvt_pk_bf16_f32 v69, v80, v81
    s_waitcnt lgkmcnt(2)
    v_mfma_f32_32x32x16_bf16 v[192:207], v[82:85], v[58:61], v[192:207]
    v_mul_f32 v74, v18, v26
    v_mul_f32 v75, v18, v27
    v_mul_f32 v76, v18, v28
    v_mul_f32 v77, v18, v29
    v_cvt_pk_bf16_f32 v62, v74, v75
    v_cvt_pk_bf16_f32 v63, v76, v77
    v_mfma_f32_32x32x16_bf16 v[208:223], v[86:89], v[58:61], v[208:223]
    v_mul_f32 v78, v19, v26
    v_mul_f32 v79, v19, v27
    v_mul_f32 v80, v19, v28
    v_mul_f32 v81, v19, v29
    v_cvt_pk_bf16_f32 v64, v78, v79
    v_cvt_pk_bf16_f32 v65, v80, v81
    v_mfma_f32_32x32x16_bf16 v[224:239], v[82:85], v[66:69], v[224:239]
    v_mul_f32 v74, v46, v54
    v_mul_f32 v75, v46, v55
    v_mul_f32 v76, v46, v56
    v_mul_f32 v77, v46, v57
    v_cvt_pk_bf16_f32 v70, v74, v75
    v_cvt_pk_bf16_f32 v71, v76, v77
    v_mfma_f32_32x32x16_bf16 v[240:255], v[86:89], v[66:69], v[240:255]
    ds_read_b128 v[82:85], v100 offset:22048
    ds_read_b128 v[86:89], v100 offset:45792
    v_mul_f32 v78, v47, v54
    v_mul_f32 v79, v47, v55
    v_mul_f32 v80, v47, v56
    v_mul_f32 v81, v47, v57
    v_cvt_pk_bf16_f32 v72, v78, v79
    v_cvt_pk_bf16_f32 v73, v80, v81
    s_waitcnt lgkmcnt(2)
    v_mfma_f32_32x32x16_bf16 v[192:207], v[90:93], v[62:65], v[192:207]
    v_mul_f32 v74, v22, v26
    v_mul_f32 v75, v22, v27
    v_mul_f32 v76, v22, v28
    v_mul_f32 v77, v22, v29
    v_cvt_pk_bf16_f32 v58, v74, v75
    v_cvt_pk_bf16_f32 v59, v76, v77
    v_mfma_f32_32x32x16_bf16 v[208:223], v[94:97], v[62:65], v[208:223]
    v_mul_f32 v78, v23, v26
    v_mul_f32 v79, v23, v27
    v_mul_f32 v80, v23, v28
    v_mul_f32 v81, v23, v29
    v_cvt_pk_bf16_f32 v60, v78, v79
    v_cvt_pk_bf16_f32 v61, v80, v81
    v_mfma_f32_32x32x16_bf16 v[224:239], v[90:93], v[70:73], v[224:239]
    v_mul_f32 v74, v50, v54
    v_mul_f32 v75, v50, v55
    v_mul_f32 v76, v50, v56
    v_mul_f32 v77, v50, v57
    v_cvt_pk_bf16_f32 v66, v74, v75
    v_cvt_pk_bf16_f32 v67, v76, v77
    v_mfma_f32_32x32x16_bf16 v[240:255], v[94:97], v[70:73], v[240:255]
    ds_read_b128 v[90:93], v100 offset:22896
    ds_read_b128 v[94:97], v100 offset:46640
    v_mul_f32 v78, v51, v54
    v_mul_f32 v79, v51, v55
    v_mul_f32 v80, v51, v56
    v_mul_f32 v81, v51, v57
    v_cvt_pk_bf16_f32 v68, v78, v79
    v_cvt_pk_bf16_f32 v69, v80, v81
    s_waitcnt lgkmcnt(2)
    v_mfma_f32_32x32x16_bf16 v[192:207], v[82:85], v[58:61], v[192:207]
    v_mul_f32_e64 v74, v26, v26 div:2
    v_mul_f32_e64 v75, v26, v27 div:2
    v_mul_f32_e64 v76, v26, v28 div:2
    v_mul_f32_e64 v77, v26, v29 div:2
    v_cvt_pk_bf16_f32 v62, v74, v75
    v_cvt_pk_bf16_f32 v63, v76, v77
    v_mfma_f32_32x32x16_bf16 v[208:223], v[86:89], v[58:61], v[208:223]
    v_mul_f32_e64 v78, v27, v26 div:2
    v_mul_f32_e64 v79, v27, v27 div:2
    v_mul_f32_e64 v80, v27, v28 div:2
    v_mul_f32_e64 v81, v27, v29 div:2
    v_cvt_pk_bf16_f32 v64, v78, v79
    v_cvt_pk_bf16_f32 v65, v80, v81
    v_mfma_f32_32x32x16_bf16 v[224:239], v[82:85], v[66:69], v[224:239]
    v_mul_f32_e64 v74, v54, v54 div:2
    v_mul_f32_e64 v75, v54, v55 div:2
    v_mul_f32_e64 v76, v54, v56 div:2
    v_mul_f32_e64 v77, v54, v57 div:2
    v_cvt_pk_bf16_f32 v70, v74, v75
    v_cvt_pk_bf16_f32 v71, v76, v77
    v_mfma_f32_32x32x16_bf16 v[240:255], v[86:89], v[66:69], v[240:255]
    v_mul_f32_e64 v78, v55, v54 div:2
    v_mul_f32_e64 v79, v55, v55 div:2
    v_mul_f32_e64 v80, v55, v56 div:2
    v_mul_f32_e64 v81, v55, v57 div:2
    v_cvt_pk_bf16_f32 v72, v78, v79
    v_cvt_pk_bf16_f32 v73, v80, v81
    s_waitcnt lgkmcnt(0)
    v_mfma_f32_32x32x16_bf16 v[192:207], v[90:93], v[62:65], v[192:207]
    v_mfma_f32_32x32x16_bf16 v[208:223], v[94:97], v[62:65], v[208:223]
    v_mfma_f32_32x32x16_bf16 v[224:239], v[90:93], v[70:73], v[224:239]
    v_mfma_f32_32x32x16_bf16 v[240:255], v[94:97], v[70:73], v[240:255]
    s_setprio 2
    s_nop 8
    v_mul_f32 v122, v192, v208
    v_mul_f32 v123, v204, v220
    v_mul_f32 v124, v193, v209
    v_fmac_f32 v123, v205, v221
    v_fmac_f32 v122, v194, v210
    v_fmac_f32 v124, v195, v211
    v_fmac_f32 v122, v196, v212
    v_fmac_f32 v124, v197, v213
    v_fmac_f32 v122, v198, v214
    v_fmac_f32 v124, v199, v215
    v_fmac_f32 v122, v200, v216
    v_fmac_f32 v124, v201, v217
    v_fmac_f32 v122, v202, v218
    v_fmac_f32 v124, v203, v219
    v_mul_f32 v126, v224, v240
    v_mul_f32 v127, v236, v252
    v_mul_f32 v128, v225, v241
    v_fmac_f32 v127, v237, v253
    v_fmac_f32 v126, v226, v242
    v_fmac_f32 v128, v227, v243
    v_fmac_f32 v126, v228, v244
    v_fmac_f32 v128, v229, v245
    v_fmac_f32 v126, v230, v246
    v_fmac_f32 v128, v231, v247
    v_fmac_f32 v126, v232, v248
    v_fmac_f32 v128, v233, v249
    v_fmac_f32 v126, v234, v250
    v_fmac_f32 v128, v235, v251
    v_cmp_gt_u32 vcc, 32, v0
    v_add_f32 v122, v122, v124
    v_add_f32 v126, v126, v128
    v_cndmask_b32 v123, 0, v123, vcc
    v_cndmask_b32 v127, 0, v127, vcc
    v_add_f32 v122, v122, v123
    v_add_f32 v126, v126, v127
    v_and_b32 v124, 1, v143
    v_lshlrev_b32 v124, 6, v124
    v_lshrrev_b32 v125, 1, v143
    v_lshl_add_u32 v124, v125, 2, v124
    s_lshl_b32 s68, s65, 8
    s_add_u32 s68, s68, 157904
    v_add_u32 v124, s68, v124
    v_add_f32_dpp v122, v122, v122 row_ror:8 row_mask:0xf bank_mask:0xf
    v_add_f32_dpp v126, v126, v126 row_ror:8 row_mask:0xf bank_mask:0xf
    s_nop 0
    v_add_f32_dpp v122, v122, v122 row_ror:4 row_mask:0xf bank_mask:0xf
    v_add_f32_dpp v126, v126, v126 row_ror:4 row_mask:0xf bank_mask:0xf
    s_nop 0
    v_add_f32_dpp v122, v122, v122 row_ror:2 row_mask:0xf bank_mask:0xf
    v_add_f32_dpp v126, v126, v126 row_ror:2 row_mask:0xf bank_mask:0xf
    s_nop 0
    v_add_f32_dpp v122, v122, v122 row_ror:1 row_mask:0xf bank_mask:0xf
    v_add_f32_dpp v126, v126, v126 row_ror:1 row_mask:0xf bank_mask:0xf
    s_mov_b32 exec_lo, 0x00010001
    s_mov_b32 exec_hi, 0x00010001
    ds_write_b32 v124, v122
    ds_write_b32 v124, v126 offset:128
    s_mov_b64 exec, -1
    s_waitcnt lgkmcnt(0)
    s_branch L_join
L_Upath:
    s_lshl_b32 s70, s65, 3
    s_add_u32 s70, s70, 52
    s_add_u32 s71, s70, 32
    s_load_dwordx16 s[44:59], s[10:11], 104
    s_load_dwordx2 s[60:61], s[10:11], s70
    s_load_dwordx2 s[62:63], s[10:11], s71
    v_lshl_add_u32 v132, v143, 2, v144
    v_and_b32 v133, 7, v132
    v_lshlrev_b32 v133, 5, v133
    v_lshl_add_u32 v133, v132, 9, v133
    v_lshl_add_u32 v133, v145, 3, v133
    v_add_u32 v188, s82, v133
    v_xor_b32 v189, 32, v188
    v_xor_b32 v190, 64, v188
    v_xor_b32 v191, 96, v188
    v_xor_b32 v192, 128, v188
    v_xor_b32 v193, 160, v188
    v_xor_b32 v194, 192, v188
    v_xor_b32 v195, 224, v188
    v_lshl_add_u32 v132, v143, 2, v144
    v_add_u32 v132, 16, v132
    v_min_u32 v132, 25, v132
    v_and_b32 v133, 7, v132
    v_lshlrev_b32 v133, 5, v133
    v_lshl_add_u32 v133, v132, 9, v133
    v_lshl_add_u32 v133, v145, 3, v133
    v_add_u32 v196, s82, v133
    v_xor_b32 v197, 32, v196
    v_xor_b32 v198, 64, v196
    v_xor_b32 v199, 96, v196
    v_xor_b32 v200, 128, v196
    v_xor_b32 v201, 160, v196
    v_xor_b32 v202, 192, v196
    v_xor_b32 v203, 224, v196
    v_mov_b32 v34, 0
    v_mov_b32 v38, 0
    v_mov_b32 v42, 0
    v_mov_b32 v46, 0
    v_mov_b32 v50, 0
    v_mov_b32 v54, 0
    v_mov_b32 v58, 0
    v_mov_b32 v62, 0
    v_mov_b32 v212, 0
    v_mov_b32 v213, 0
    v_mov_b32 v214, 0
    v_mov_b32 v215, 0
    v_lshlrev_b32 v122, 4, v0
    v_add_u32 v122, 154112, v122
    v_cmp_gt_u32 s[78:79], 10, v142
    s_lshl_b32 s84, s65, 2
    s_lshl_b32 s85, 1, s84
    s_lshl_b32 s86, s85, 16
    s_waitcnt lgkmcnt(0)
    s_mov_b32 s57, 0
    s_mov_b32 s58, 0
    s_mov_b32 s59, 0
    s_mov_b32 exec_lo, s85
    s_mov_b32 exec_hi, 0
    v_mov_b32 v212, s44
    v_mov_b32 v213, s45
    v_mov_b32 v214, s52
    v_mov_b32 v215, s53
    s_mov_b32 exec_lo, s86
    v_mov_b32 v212, s46
    v_mov_b32 v213, s47
    v_mov_b32 v214, s54
    v_mov_b32 v215, s55
    s_mov_b32 exec_lo, 0
    s_mov_b32 exec_hi, s85
    v_mov_b32 v212, s48
    v_mov_b32 v213, s49
    v_mov_b32 v214, s56
    v_mov_b32 v215, s57
    s_mov_b32 exec_hi, s86
    v_mov_b32 v212, s50
    v_mov_b32 v213, s51
    v_mov_b32 v214, s58
    v_mov_b32 v215, s59
    s_mov_b64 exec, -1
    s_cmp_le_u32 s65, 2
    s_cselect_b32 s62, s62, 0
    s_cmp_le_u32 s65, 1
    s_cselect_b32 s63, s63, 0
    s_lshl_b32 s44, s60, 16
    s_and_b32 s45, s60, 0xffff0000
    s_lshl_b32 s46, s61, 16
    s_and_b32 s47, s61, 0xffff0000
    s_lshl_b32 s48, s62, 16
    s_and_b32 s49, s62, 0xffff0000
    s_lshl_b32 s50, s63, 16
    s_and_b32 s51, s63, 0xffff0000
    s_waitcnt vmcnt(0)
    v_bfe_u32 v132, v142, 1, 1
    v_mul_u32_u24 v133, 420, v132
    v_and_b32 v134, 1, v142
    v_lshl_add_u32 v133, v134, 3, v133
    s_lshl_b32 s84, s67, 4
    v_lshrrev_b32 v134, 2, v142
    v_add_u32 v132, 1, v143
    v_mul_u32_u24 v132, v132, v143
    v_cmp_le_u32 s[72:73], v134, v143
    v_lshrrev_b32 v132, 1, v132
    v_cmp_ge_u32 s[74:75], 2, v143
    v_add_u32 v132, v132, v134
    s_movk_i32 s86, 848
    v_add_u32 v133, s84, v133
    v_lshlrev_b32 v136, 2, v0
    v_mad_u32_u24 v135, v132, s86, v133
    s_and_b64 s[76:77], s[72:73], s[74:75]
    v_add_u32 v136, 262144, v136
    s_movk_i32 s85, 3392
    v_cndmask_b32 v146, v136, v135, s[72:73]
    v_mad_u32_u24 v135, v143, s85, v135
    v_xor_b32 v149, 4, v146
    v_add_u32 v135, 8480, v135
    v_cndmask_b32 v147, v136, v135, s[74:75]
    v_add_u32 v135, 3392, v135
    v_xor_b32 v150, 4, v147
    v_cndmask_b32 v148, v136, v135, s[76:77]
    v_xor_b32 v151, 4, v148
    ds_read_b64_tr_b16 v[68:69], v188 offset:0
    ds_read_b64_tr_b16 v[70:71], v196 offset:0
    ds_read_b64_tr_b16 v[72:73], v189 offset:0
    ds_read_b64_tr_b16 v[74:75], v197 offset:0
    ds_read_b64_tr_b16 v[76:77], v190 offset:0
    ds_read_b64_tr_b16 v[78:79], v198 offset:0
    ds_read_b64_tr_b16 v[80:81], v191 offset:0
    ds_read_b64_tr_b16 v[82:83], v199 offset:0
    ds_read_b64_tr_b16 v[84:85], v192 offset:0
    ds_read_b64_tr_b16 v[86:87], v200 offset:0
    ds_read_b64_tr_b16 v[88:89], v193 offset:0
    ds_read_b64_tr_b16 v[90:91], v201 offset:0
    ds_read_b64_tr_b16 v[92:93], v194 offset:0
    ds_read_b64_tr_b16 v[94:95], v202 offset:0
    ds_read_b64_tr_b16 v[96:97], v195 offset:0
    ds_read_b64_tr_b16 v[98:99], v203 offset:0
    s_waitcnt lgkmcnt(12)
    v_mfma_f32_16x16x32_bf16 v[2:5], v[212:215], v[68:71], 0
    v_mfma_f32_16x16x32_bf16 v[6:9], v[212:215], v[72:75], 0
    ds_read_b64_tr_b16 v[68:69], v188 offset:256
    ds_read_b64_tr_b16 v[70:71], v196 offset:256
    ds_read_b64_tr_b16 v[72:73], v189 offset:256
    ds_read_b64_tr_b16 v[74:75], v197 offset:256
    s_waitcnt lgkmcnt(12)
    v_mfma_f32_16x16x32_bf16 v[10:13], v[212:215], v[76:79], 0
    v_mfma_f32_16x16x32_bf16 v[14:17], v[212:215], v[80:83], 0
    ds_read_b64_tr_b16 v[76:77], v190 offset:256
    ds_read_b64_tr_b16 v[78:79], v198 offset:256
    ds_read_b64_tr_b16 v[80:81], v191 offset:256
    ds_read_b64_tr_b16 v[82:83], v199 offset:256
    s_waitcnt lgkmcnt(12)
    v_mfma_f32_16x16x32_bf16 v[18:21], v[212:215], v[84:87], 0
    v_mfma_f32_16x16x32_bf16 v[22:25], v[212:215], v[88:91], 0
    ds_read_b64_tr_b16 v[84:85], v192 offset:256
    ds_read_b64_tr_b16 v[86:87], v200 offset:256
    ds_read_b64_tr_b16 v[88:89], v193 offset:256
    ds_read_b64_tr_b16 v[90:91], v201 offset:256
    s_waitcnt lgkmcnt(12)
    v_mfma_f32_16x16x32_bf16 v[26:29], v[212:215], v[92:95], 0
    v_mfma_f32_16x16x32_bf16 v[30:33], v[212:215], v[96:99], 0
    s_cmp_eq_u32 s65, 3
    s_cbranch_scc1 L_u2done
    ds_read_b64_tr_b16 v[92:93], v194 offset:256
    ds_read_b64_tr_b16 v[94:95], v202 offset:256
    ds_read_b64_tr_b16 v[96:97], v195 offset:256
    ds_read_b64_tr_b16 v[98:99], v203 offset:256
    s_waitcnt lgkmcnt(12)
    v_mfma_f32_16x16x32_bf16 v[34:37], v[212:215], v[68:71], 0
    v_mfma_f32_16x16x32_bf16 v[38:41], v[212:215], v[72:75], 0
    s_waitcnt lgkmcnt(8)
    v_mfma_f32_16x16x32_bf16 v[42:45], v[212:215], v[76:79], 0
    v_mfma_f32_16x16x32_bf16 v[46:49], v[212:215], v[80:83], 0
    s_cmp_eq_u32 s65, 2
    s_cbranch_scc1 L_u2done
    s_waitcnt lgkmcnt(4)
    v_mfma_f32_16x16x32_bf16 v[50:53], v[212:215], v[84:87], 0
    v_mfma_f32_16x16x32_bf16 v[54:57], v[212:215], v[88:91], 0
    s_waitcnt lgkmcnt(0)
    v_mfma_f32_16x16x32_bf16 v[58:61], v[212:215], v[92:95], 0
    v_mfma_f32_16x16x32_bf16 v[62:65], v[212:215], v[96:99], 0
L_u2done:
    s_mov_b32 s88, 0xffff
    s_mov_b32 s89, 0
    s_lshl_b32 s68, s65, 4
    v_cvt_pk_bf16_f32 v204, v2, v10
    s_nop 0
    v_cvt_pk_bf16_f32 v205, v18, v26
    v_cvt_pk_bf16_f32 v206, v34, v42
    v_cvt_pk_bf16_f32 v207, v50, v58
    v_cndmask_b32 v6, 0, v6, s[78:79]
    v_cndmask_b32 v14, 0, v14, s[78:79]
    v_cndmask_b32 v22, 0, v22, s[78:79]
    v_cndmask_b32 v30, 0, v30, s[78:79]
    v_cndmask_b32 v38, 0, v38, s[78:79]
    v_cndmask_b32 v46, 0, v46, s[78:79]
    v_cndmask_b32 v54, 0, v54, s[78:79]
    v_cndmask_b32 v62, 0, v62, s[78:79]
    s_mov_b32 exec_lo, 0x04000400
    s_mov_b32 exec_hi, 0x04000400
    v_mov_b32 v6, s44
    v_mov_b32 v14, s45
    v_mov_b32 v22, s46
    v_mov_b32 v30, s47
    v_mov_b32 v38, s48
    v_mov_b32 v46, s49
    v_mov_b32 v54, s50
    v_mov_b32 v62, s51
    s_mov_b64 exec, -1
    v_cvt_pk_bf16_f32 v208, v6, v14
    v_cvt_pk_bf16_f32 v209, v22, v30
    v_cvt_pk_bf16_f32 v210, v38, v46
    v_cvt_pk_bf16_f32 v211, v54, v62
    s_lshl_b64 exec, s[88:89], s68
    ds_write_b128 v122, v[204:207]
    ds_write_b128 v122, v[208:211] offset:1024
    s_mov_b64 exec, -1
    s_cmp_lt_u32 s65, 2
    s_cselect_b32 s72, 14, 12
    s_mov_b32 s85, 87382
    s_cselect_b32 s73, 74899, s85
    s_cselect_b32 s74, 0, 2
    s_lshl_b32 s75, s72, 4
    s_lshl_b32 s84, s67, 5
    s_movk_i32 s86, 832
    s_sub_u32 s86, s86, s75
    v_add_u32 v132, 0, v0
    v_mul_u32_u24 v134, s73, v132
    v_lshrrev_b32 v134, 20, v134
    v_lshrrev_b32 v135, 1, v134
    v_and_b32 v135, s74, v135
    v_xor_b32 v132, v132, v135
    v_lshl_add_u32 v132, v132, 4, s84
    v_mad_u32_u24 v100, v134, s86, v132
    v_add_u32 v132, 64, v0
    v_mul_u32_u24 v134, s73, v132
    v_lshrrev_b32 v134, 20, v134
    v_lshrrev_b32 v135, 1, v134
    v_and_b32 v135, s74, v135
    v_xor_b32 v132, v132, v135
    v_lshl_add_u32 v132, v132, 4, s84
    v_mad_u32_u24 v101, v134, s86, v132
    v_add_u32 v132, 128, v0
    v_mul_u32_u24 v134, s73, v132
    v_lshrrev_b32 v134, 20, v134
    v_lshrrev_b32 v135, 1, v134
    v_and_b32 v135, s74, v135
    v_xor_b32 v132, v132, v135
    v_lshl_add_u32 v132, v132, 4, s84
    v_mad_u32_u24 v102, v134, s86, v132
    v_add_u32 v132, 192, v0
    v_mul_u32_u24 v134, s73, v132
    v_lshrrev_b32 v134, 20, v134
    v_lshrrev_b32 v135, 1, v134
    v_and_b32 v135, s74, v135
    v_xor_b32 v132, v132, v135
    v_lshl_add_u32 v132, v132, 4, s84
    v_mad_u32_u24 v103, v134, s86, v132
    v_add_u32 v132, 256, v0
    v_mul_u32_u24 v134, s73, v132
    v_lshrrev_b32 v134, 20, v134
    v_lshrrev_b32 v135, 1, v134
    v_and_b32 v135, s74, v135
    v_xor_b32 v132, v132, v135
    v_lshl_add_u32 v132, v132, 4, s84
    v_mad_u32_u24 v104, v134, s86, v132
    v_add_u32 v132, 320, v0
    v_mul_u32_u24 v134, s73, v132
    v_lshrrev_b32 v134, 20, v134
    v_lshrrev_b32 v135, 1, v134
    v_and_b32 v135, s74, v135
    v_xor_b32 v132, v132, v135
    v_lshl_add_u32 v132, v132, 4, s84
    v_mad_u32_u24 v105, v134, s86, v132
    v_add_u32 v132, 384, v0
    v_mul_u32_u24 v134, s73, v132
    v_lshrrev_b32 v134, 20, v134
    v_lshrrev_b32 v135, 1, v134
    v_and_b32 v135, s74, v135
    v_xor_b32 v132, v132, v135
    v_lshl_add_u32 v132, v132, 4, s84
    v_mad_u32_u24 v106, v134, s86, v132
    s_lshl_b32 s92, s67, 10
    s_add_u32 s92, s92, 47616
    v_lshrrev_b32 v133, 1, v143
    v_and_b32 v134, 1, v143
    v_lshlrev_b32 v132, 4, v133
    v_lshl_add_u32 v132, v134, 2, v132
    v_add_u32 v132, v132, v144
    v_mul_u32_u24 v132, s75, v132
    v_lshl_add_u32 v132, v145, 3, v132
    v_add_u32 v132, s92, v132
    s_lshl_b32 s85, s74, 4
    v_lshlrev_b32 v135, 5, v134
    v_and_b32 v135, s85, v135
    v_add_u32 v108, v132, v135
    v_sub_u32 v109, v132, v135
    v_add_u32 v109, 32, v109
    s_lshl_b32 s85, s75, 3
    v_add_u32 v110, s85, v108
    v_add_u32 v111, s85, v109
    v_add_u32 v112, 53248, v108
    v_add_u32 v113, 53248, v109
    v_add_u32 v114, 53248, v110
    v_add_u32 v115, 53248, v111
    s_movk_i32 s85, 912
    v_lshlrev_b32 v132, 5, v133
    v_lshl_add_u32 v132, v134, 3, v132
    v_mad_u32_u24 v132, v142, s85, v132
    v_add_u32 v116, 127488, v132
    s_waitcnt lgkmcnt(0)
    s_barrier
    ds_read_b128 v[204:207], v122 offset:0
    ds_read_b128 v[208:211], v122 offset:1024
    ds_read_b64_tr_b16 v[68:69], v188 offset:53248
    ds_read_b64_tr_b16 v[70:71], v196 offset:53248
    ds_read_b64_tr_b16 v[72:73], v189 offset:53248
    ds_read_b64_tr_b16 v[74:75], v197 offset:53248
    ds_read_b64_tr_b16 v[76:77], v190 offset:53248
    ds_read_b64_tr_b16 v[78:79], v198 offset:53248
    ds_read_b64_tr_b16 v[80:81], v191 offset:53248
    ds_read_b64_tr_b16 v[82:83], v199 offset:53248
    ds_read_b64_tr_b16 v[84:85], v192 offset:53248
    ds_read_b64_tr_b16 v[86:87], v200 offset:53248
    ds_read_b64_tr_b16 v[88:89], v193 offset:53248
    ds_read_b64_tr_b16 v[90:91], v201 offset:53248
    ds_read_b64_tr_b16 v[92:93], v194 offset:53248
    ds_read_b64_tr_b16 v[94:95], v202 offset:53248
    ds_read_b64_tr_b16 v[96:97], v195 offset:53248
    ds_read_b64_tr_b16 v[98:99], v203 offset:53248
    s_waitcnt lgkmcnt(12)
    v_cndmask_b32 v72, 0, v72, s[78:79]
    v_cndmask_b32 v73, 0, v73, s[78:79]
    v_cndmask_b32 v74, 0, v74, s[78:79]
    v_cndmask_b32 v75, 0, v75, s[78:79]
    v_mfma_f32_16x16x32_bf16 v[152:155], v[68:71], v[204:207], 0
    s_nop 0
    v_mfma_f32_16x16x32_bf16 v[156:159], v[72:75], v[204:207], 0
    v_mfma_f32_16x16x32_bf16 v[160:163], v[72:75], v[208:211], 0
    v_mfma_f32_16x16x32_bf16 v[152:155], v[204:207], v[68:71], v[152:155]
    v_mfma_f32_16x16x32_bf16 v[156:159], v[208:211], v[68:71], v[156:159]
    v_mfma_f32_16x16x32_bf16 v[160:163], v[208:211], v[72:75], v[160:163]
    ds_read_b64_tr_b16 v[68:69], v188 offset:53504
    ds_read_b64_tr_b16 v[70:71], v196 offset:53504
    ds_read_b64_tr_b16 v[72:73], v189 offset:53504
    ds_read_b64_tr_b16 v[74:75], v197 offset:53504
    s_waitcnt lgkmcnt(12)
    v_cndmask_b32 v80, 0, v80, s[78:79]
    v_cndmask_b32 v81, 0, v81, s[78:79]
    v_cndmask_b32 v82, 0, v82, s[78:79]
    v_cndmask_b32 v83, 0, v83, s[78:79]
    v_mfma_f32_16x16x32_bf16 v[164:167], v[76:79], v[204:207], 0
    v_cvt_pk_bf16_f32 v176, v152, v153
    v_cvt_pk_bf16_f32 v177, v154, v155
    v_mfma_f32_16x16x32_bf16 v[168:171], v[80:83], v[204:207], 0
    v_cvt_pk_bf16_f32 v178, v156, v157
    v_cvt_pk_bf16_f32 v179, v158, v159
    v_mfma_f32_16x16x32_bf16 v[172:175], v[80:83], v[208:211], 0
    v_cvt_pk_bf16_f32 v180, v160, v161
    v_cvt_pk_bf16_f32 v181, v162, v163
    v_mfma_f32_16x16x32_bf16 v[164:167], v[204:207], v[76:79], v[164:167]
    ds_write_b32 v146, v176 offset:23744
    ds_write_b32 v149, v177 offset:23744
    v_mfma_f32_16x16x32_bf16 v[168:171], v[208:211], v[76:79], v[168:171]
    ds_write_b32 v147, v178 offset:23744
    ds_write_b32 v150, v179 offset:23744
    v_mfma_f32_16x16x32_bf16 v[172:175], v[208:211], v[80:83], v[172:175]
    ds_write_b32 v148, v180 offset:23744
    ds_write_b32 v151, v181 offset:23744
    ds_read_b64_tr_b16 v[76:77], v190 offset:53504
    ds_read_b64_tr_b16 v[78:79], v198 offset:53504
    ds_read_b64_tr_b16 v[80:81], v191 offset:53504
    ds_read_b64_tr_b16 v[82:83], v199 offset:53504
    s_waitcnt lgkmcnt(15)
    v_cndmask_b32 v88, 0, v88, s[78:79]
    v_cndmask_b32 v89, 0, v89, s[78:79]
    v_cndmask_b32 v90, 0, v90, s[78:79]
    v_cndmask_b32 v91, 0, v91, s[78:79]
    v_mfma_f32_16x16x32_bf16 v[152:155], v[84:87], v[204:207], 0
    v_cvt_pk_bf16_f32 v176, v164, v165
    v_cvt_pk_bf16_f32 v177, v166, v167
    v_mfma_f32_16x16x32_bf16 v[156:159], v[88:91], v[204:207], 0
    v_cvt_pk_bf16_f32 v178, v168, v169
    v_cvt_pk_bf16_f32 v179, v170, v171
    v_mfma_f32_16x16x32_bf16 v[160:163], v[88:91], v[208:211], 0
    v_cvt_pk_bf16_f32 v180, v172, v173
    v_cvt_pk_bf16_f32 v181, v174, v175
    v_mfma_f32_16x16x32_bf16 v[152:155], v[204:207], v[84:87], v[152:155]
    ds_write_b32 v146, v176 offset:23760
    ds_write_b32 v149, v177 offset:23760
    v_mfma_f32_16x16x32_bf16 v[156:159], v[208:211], v[84:87], v[156:159]
    ds_write_b32 v147, v178 offset:23760
    ds_write_b32 v150, v179 offset:23760
    v_mfma_f32_16x16x32_bf16 v[160:163], v[208:211], v[88:91], v[160:163]
    ds_write_b32 v148, v180 offset:23760
    ds_write_b32 v151, v181 offset:23760
    ds_read_b64_tr_b16 v[84:85], v192 offset:53504
    ds_read_b64_tr_b16 v[86:87], v200 offset:53504
    ds_read_b64_tr_b16 v[88:89], v193 offset:53504
    ds_read_b64_tr_b16 v[90:91], v201 offset:53504
    s_waitcnt lgkmcnt(15)
    v_cndmask_b32 v96, 0, v96, s[78:79]
    v_cndmask_b32 v97, 0, v97, s[78:79]
    v_cndmask_b32 v98, 0, v98, s[78:79]
    v_cndmask_b32 v99, 0, v99, s[78:79]
    v_mfma_f32_16x16x32_bf16 v[164:167], v[92:95], v[204:207], 0
    v_cvt_pk_bf16_f32 v176, v152, v153
    v_cvt_pk_bf16_f32 v177, v154, v155
    v_mfma_f32_16x16x32_bf16 v[168:171], v[96:99], v[204:207], 0
    v_cvt_pk_bf16_f32 v178, v156, v157
    v_cvt_pk_bf16_f32 v179, v158, v159
    v_mfma_f32_16x16x32_bf16 v[172:175], v[96:99], v[208:211], 0
    v_cvt_pk_bf16_f32 v180, v160, v161
    v_cvt_pk_bf16_f32 v181, v162, v163
    v_mfma_f32_16x16x32_bf16 v[164:167], v[204:207], v[92:95], v[164:167]
    ds_write_b32 v146, v176 offset:23776
    ds_write_b32 v149, v177 offset:23776
    v_mfma_f32_16x16x32_bf16 v[168:171], v[208:211], v[92:95], v[168:171]
    ds_write_b32 v147, v178 offset:23776
    ds_write_b32 v150, v179 offset:23776
    v_mfma_f32_16x16x32_bf16 v[172:175], v[208:211], v[96:99], v[172:175]
    ds_write_b32 v148, v180 offset:23776
    ds_write_b32 v151, v181 offset:23776
    s_waitcnt lgkmcnt(15)
    v_cndmask_b32 v72, 0, v72, s[78:79]
    v_cndmask_b32 v73, 0, v73, s[78:79]
    v_cndmask_b32 v74, 0, v74, s[78:79]
    v_cndmask_b32 v75, 0, v75, s[78:79]
    v_mfma_f32_16x16x32_bf16 v[152:155], v[68:71], v[204:207], 0
    v_cvt_pk_bf16_f32 v176, v164, v165
    v_cvt_pk_bf16_f32 v177, v166, v167
    v_mfma_f32_16x16x32_bf16 v[156:159], v[72:75], v[204:207], 0
    v_cvt_pk_bf16_f32 v178, v168, v169
    v_cvt_pk_bf16_f32 v179, v170, v171
    v_mfma_f32_16x16x32_bf16 v[160:163], v[72:75], v[208:211], 0
    v_cvt_pk_bf16_f32 v180, v172, v173
    v_cvt_pk_bf16_f32 v181, v174, v175
    v_mfma_f32_16x16x32_bf16 v[152:155], v[204:207], v[68:71], v[152:155]
    ds_write_b32 v146, v176 offset:23792
    ds_write_b32 v149, v177 offset:23792
    v_mfma_f32_16x16x32_bf16 v[156:159], v[208:211], v[68:71], v[156:159]
    ds_write_b32 v147, v178 offset:23792
    ds_write_b32 v150, v179 offset:23792
    v_mfma_f32_16x16x32_bf16 v[160:163], v[208:211], v[72:75], v[160:163]
    ds_write_b32 v148, v180 offset:23792
    ds_write_b32 v151, v181 offset:23792
    s_waitcnt lgkmcnt(15)
    v_cndmask_b32 v80, 0, v80, s[78:79]
    v_cndmask_b32 v81, 0, v81, s[78:79]
    v_cndmask_b32 v82, 0, v82, s[78:79]
    v_cndmask_b32 v83, 0, v83, s[78:79]
    v_mfma_f32_16x16x32_bf16 v[164:167], v[76:79], v[204:207], 0
    v_cvt_pk_bf16_f32 v176, v152, v153
    v_cvt_pk_bf16_f32 v177, v154, v155
    v_mfma_f32_16x16x32_bf16 v[168:171], v[80:83], v[204:207], 0
    v_cvt_pk_bf16_f32 v178, v156, v157
    v_cvt_pk_bf16_f32 v179, v158, v159
    v_mfma_f32_16x16x32_bf16 v[172:175], v[80:83], v[208:211], 0
    v_cvt_pk_bf16_f32 v180, v160, v161
    v_cvt_pk_bf16_f32 v181, v162, v163
    v_mfma_f32_16x16x32_bf16 v[164:167], v[204:207], v[76:79], v[164:167]
    ds_write_b32 v146, v176 offset:23808
    ds_write_b32 v149, v177 offset:23808
    v_mfma_f32_16x16x32_bf16 v[168:171], v[208:211], v[76:79], v[168:171]
    ds_write_b32 v147, v178 offset:23808
    ds_write_b32 v150, v179 offset:23808
    v_mfma_f32_16x16x32_bf16 v[172:175], v[208:211], v[80:83], v[172:175]
    ds_write_b32 v148, v180 offset:23808
    ds_write_b32 v151, v181 offset:23808
    s_cmp_ge_u32 s65, 2
    s_cbranch_scc1 L_tlast
    s_waitcnt lgkmcnt(15)
    v_cndmask_b32 v88, 0, v88, s[78:79]
    v_cndmask_b32 v89, 0, v89, s[78:79]
    v_cndmask_b32 v90, 0, v90, s[78:79]
    v_cndmask_b32 v91, 0, v91, s[78:79]
    v_mfma_f32_16x16x32_bf16 v[152:155], v[84:87], v[204:207], 0
    v_cvt_pk_bf16_f32 v176, v164, v165
    v_cvt_pk_bf16_f32 v177, v166, v167
    v_mfma_f32_16x16x32_bf16 v[156:159], v[88:91], v[204:207], 0
    v_cvt_pk_bf16_f32 v178, v168, v169
    v_cvt_pk_bf16_f32 v179, v170, v171
    v_mfma_f32_16x16x32_bf16 v[160:163], v[88:91], v[208:211], 0
    v_cvt_pk_bf16_f32 v180, v172, v173
    v_cvt_pk_bf16_f32 v181, v174, v175
    v_mfma_f32_16x16x32_bf16 v[152:155], v[204:207], v[84:87], v[152:155]
    ds_write_b32 v146, v176 offset:23824
    ds_write_b32 v149, v177 offset:23824
    v_mfma_f32_16x16x32_bf16 v[156:159], v[208:211], v[84:87], v[156:159]
    ds_write_b32 v147, v178 offset:23824
    ds_write_b32 v150, v179 offset:23824
    v_mfma_f32_16x16x32_bf16 v[160:163], v[208:211], v[88:91], v[160:163]
    ds_write_b32 v148, v180 offset:23824
    ds_write_b32 v151, v181 offset:23824
    v_cvt_pk_bf16_f32 v176, v152, v153
    v_cvt_pk_bf16_f32 v177, v154, v155
    s_nop 0
    v_cvt_pk_bf16_f32 v178, v156, v157
    v_cvt_pk_bf16_f32 v179, v158, v159
    s_nop 0
    v_cvt_pk_bf16_f32 v180, v160, v161
    v_cvt_pk_bf16_f32 v181, v162, v163
    ds_write_b32 v146, v176 offset:23840
    ds_write_b32 v149, v177 offset:23840
    ds_write_b32 v147, v178 offset:23840
    ds_write_b32 v150, v179 offset:23840
    ds_write_b32 v148, v180 offset:23840
    ds_write_b32 v151, v181 offset:23840
    s_branch L_tend
L_tlast:
    v_cvt_pk_bf16_f32 v176, v164, v165
    v_cvt_pk_bf16_f32 v177, v166, v167
    v_cvt_pk_bf16_f32 v178, v168, v169
    v_cvt_pk_bf16_f32 v179, v170, v171
    v_cvt_pk_bf16_f32 v180, v172, v173
    v_cvt_pk_bf16_f32 v181, v174, v175
    ds_write_b32 v146, v176 offset:23824
    ds_write_b32 v149, v177 offset:23824
    ds_write_b32 v147, v178 offset:23824
    ds_write_b32 v150, v179 offset:23824
    ds_write_b32 v148, v180 offset:23824
    ds_write_b32 v151, v181 offset:23824
L_tend:
    s_waitcnt lgkmcnt(0)
    s_mov_b32 s71, 0
    s_add_u32 m0, s92, 0
    s_nop 0
    buffer_load_dwordx4 v100, s[36:39], s71 offen lds
    s_add_u32 m0, s92, 1024
    s_nop 0
    buffer_load_dwordx4 v101, s[36:39], s71 offen lds
    s_add_u32 m0, s92, 2048
    s_nop 0
    buffer_load_dwordx4 v102, s[36:39], s71 offen lds
    s_add_u32 m0, s92, 3072
    s_nop 0
    buffer_load_dwordx4 v103, s[36:39], s71 offen lds
    s_add_u32 m0, s92, 4096
    s_nop 0
    buffer_load_dwordx4 v104, s[36:39], s71 offen lds
    s_add_u32 m0, s92, 5120
    s_nop 0
    buffer_load_dwordx4 v105, s[36:39], s71 offen lds
    s_cmp_ge_u32 s65, 2
    s_cbranch_scc1 L_dma_U0
    s_add_u32 m0, s92, 6144
    s_nop 0
    buffer_load_dwordx4 v106, s[36:39], s71 offen lds
L_dma_U0:
    v_mov_b32 v118, 158912
    v_mov_b32 v119, 1
    s_lshl_b32 s84, s67, 5
    s_add_u32 s84, s84, 156224
    v_lshlrev_b32 v133, 1, v142
    v_add_u32 v133, s84, v133
    v_mov_b32 v60, 0
    v_mov_b32 v236, 0
    v_mov_b32 v61, 0
    v_mov_b32 v237, 0
    v_mov_b32 v62, 0
    v_mov_b32 v238, 0
    v_mov_b32 v63, 0
    v_mov_b32 v239, 0
    v_mov_b32 v64, 0
    v_mov_b32 v240, 0
    v_mov_b32 v65, 0
    v_mov_b32 v241, 0
    v_mov_b32 v66, 0
    v_mov_b32 v242, 0
    ds_read_u16_d16_hi v60, v133 offset:0
    ds_read_u16_d16_hi v236, v133 offset:832
    ds_read_u16_d16_hi v61, v133 offset:32
    ds_read_u16_d16_hi v237, v133 offset:864
    ds_read_u16_d16_hi v62, v133 offset:64
    ds_read_u16_d16_hi v238, v133 offset:896
    ds_read_u16_d16_hi v63, v133 offset:96
    ds_read_u16_d16_hi v239, v133 offset:928
    ds_read_u16_d16_hi v64, v133 offset:128
    ds_read_u16_d16_hi v240, v133 offset:960
    ds_read_u16_d16_hi v65, v133 offset:160
    ds_read_u16_d16_hi v241, v133 offset:992
    ds_read_u16_d16_hi v66, v133 offset:192
    ds_read_u16_d16_hi v242, v133 offset:1024
    v_mov_b32 v244, 0xbdd2d3e8
    v_mov_b32 v245, 0xbdd2d3e8
    v_mov_b32 v246, 0xc0135761
    v_mov_b32 v247, 0xc0135761
    v_mov_b32 v248, 1.0
    v_mov_b32 v249, 1.0
    s_waitcnt lgkmcnt(0)
    v_mov_b32 v208, v60
    v_mov_b32 v209, v60
    v_mov_b32 v210, v60
    v_mov_b32 v211, v60
    v_mov_b32 v212, v61
    v_mov_b32 v213, v61
    v_mov_b32 v214, v61
    v_mov_b32 v215, v61
    v_mov_b32 v216, v62
    v_mov_b32 v217, v62
    v_mov_b32 v218, v62
    v_mov_b32 v219, v62
    v_mov_b32 v220, v63
    v_mov_b32 v221, v63
    v_mov_b32 v222, v63
    v_mov_b32 v223, v63
    v_mov_b32 v224, v64
    v_mov_b32 v225, v64
    v_mov_b32 v226, v64
    v_mov_b32 v227, v64
    v_mov_b32 v228, v65
    v_mov_b32 v229, v65
    v_mov_b32 v230, v65
    v_mov_b32 v231, v65
    v_mov_b32 v232, v66
    v_mov_b32 v233, v66
    v_mov_b32 v234, v66
    v_mov_b32 v235, v66
    s_waitcnt lgkmcnt(0)
    s_barrier
    s_cmp_ge_u32 s65, 2
    s_cselect_b64 vcc, -1, 0
    s_mov_b32 s71, 26624
    s_add_u32 m0, s92, 26624
    s_nop 0
    buffer_load_dwordx4 v100, s[36:39], s71 offen lds
    s_add_u32 m0, s92, 27648
    s_nop 0
    buffer_load_dwordx4 v101, s[36:39], s71 offen lds
    s_add_u32 m0, s92, 28672
    s_nop 0
    buffer_load_dwordx4 v102, s[36:39], s71 offen lds
    s_add_u32 m0, s92, 29696
    s_nop 0
    buffer_load_dwordx4 v103, s[36:39], s71 offen lds
    s_add_u32 m0, s92, 30720
    s_nop 0
    buffer_load_dwordx4 v104, s[36:39], s71 offen lds
    s_add_u32 m0, s92, 31744
    s_nop 0
    buffer_load_dwordx4 v105, s[36:39], s71 offen lds
    s_cmp_ge_u32 s65, 2
    s_cbranch_scc1 L_dma_C1
    s_add_u32 m0, s92, 32768
    s_nop 0
    buffer_load_dwordx4 v106, s[36:39], s71 offen lds
L_dma_C1:
    s_mov_b32 s71, 53248
    s_add_u32 m0, s92, 53248
    s_nop 0
    buffer_load_dwordx4 v100, s[36:39], s71 offen lds
    s_add_u32 m0, s92, 54272
    s_nop 0
    buffer_load_dwordx4 v101, s[36:39], s71 offen lds
    s_add_u32 m0, s92, 55296
    s_nop 0
    buffer_load_dwordx4 v102, s[36:39], s71 offen lds
    s_add_u32 m0, s92, 56320
    s_nop 0
    buffer_load_dwordx4 v103, s[36:39], s71 offen lds
    s_add_u32 m0, s92, 57344
    s_nop 0
    buffer_load_dwordx4 v104, s[36:39], s71 offen lds
    s_add_u32 m0, s92, 58368
    s_nop 0
    buffer_load_dwordx4 v105, s[36:39], s71 offen lds
    s_cmp_ge_u32 s65, 2
    s_cbranch_scc1 L_dma_C2
    s_add_u32 m0, s92, 59392
    s_nop 0
    buffer_load_dwordx4 v106, s[36:39], s71 offen lds
L_dma_C2:
L_xl_dnn:
    ds_read_b32 v120, v118 offset:4
    s_waitcnt lgkmcnt(0)
    v_readfirstlane_b32 s68, v120
    s_nop 3
    s_cmp_ge_u32 s68, 4
    s_cbranch_scc0 L_xl_dnn
    ds_read_b64 v[152:153], v116 offset:0
    ds_read_b64 v[154:155], v116 offset:16
    ds_read_b64 v[156:157], v116 offset:64
    ds_read_b64 v[158:159], v116 offset:80
    ds_read_b64 v[160:161], v116 offset:128
    ds_read_b64 v[162:163], v116 offset:144
    ds_read_b64 v[164:165], v116 offset:192
    ds_read_b64 v[166:167], v116 offset:208
    ds_read_b64 v[168:169], v116 offset:256
    ds_read_b64 v[170:171], v116 offset:272
    ds_read_b64 v[172:173], v116 offset:320
    ds_read_b64 v[174:175], v116 offset:336
    ds_read_b64 v[176:177], v116 offset:384
    ds_read_b64 v[178:179], v116 offset:400
    ds_read_b64 v[180:181], v116 offset:448
    ds_read_b64 v[182:183], v116 offset:464
    ds_read_b64 v[184:185], v116 offset:512
    ds_read_b64 v[186:187], v116 offset:528
    ds_read_b64 v[188:189], v116 offset:576
    ds_read_b64 v[190:191], v116 offset:592
    ds_read_b64 v[192:193], v116 offset:640
    ds_read_b64 v[194:195], v116 offset:656
    ds_read_b64 v[196:197], v116 offset:704
    ds_read_b64 v[198:199], v116 offset:720
    ds_read_b64 v[200:201], v116 offset:768
    ds_read_b64 v[202:203], v116 offset:784
    s_waitcnt lgkmcnt(0)
    s_mov_b64 exec, 1
    ds_add_u32 v118, v119
    s_mov_b64 exec, -1
    s_cbranch_vccnz L_vw6_0
    s_waitcnt vmcnt(7)
    s_branch L_vwd_0
L_vw6_0:
    s_waitcnt vmcnt(6)
L_vwd_0:
    ds_read_b64_tr_b16 v[2:3], v108 offset:0
    ds_read_b64_tr_b16 v[4:5], v110 offset:0
    ds_read_b64_tr_b16 v[6:7], v109 offset:0
    ds_read_b64_tr_b16 v[8:9], v111 offset:0
    ds_read_b64_tr_b16 v[10:11], v108 offset:64
    ds_read_b64_tr_b16 v[12:13], v110 offset:64
    ds_read_b64_tr_b16 v[14:15], v109 offset:64
    ds_read_b64_tr_b16 v[16:17], v111 offset:64
    ds_read_b64_tr_b16 v[18:19], v108 offset:128
    ds_read_b64_tr_b16 v[20:21], v110 offset:128
    ds_read_b64_tr_b16 v[22:23], v109 offset:128
    ds_read_b64_tr_b16 v[24:25], v111 offset:128
    s_cbranch_vccnz L_r6_0
    ds_read_b64_tr_b16 v[26:27], v108 offset:192
    ds_read_b64_tr_b16 v[28:29], v110 offset:192
L_r6_0:
L_xspin:
    ds_read_b32 v120, v118
    s_waitcnt lgkmcnt(0)
    v_readfirstlane_b32 s68, v120
    s_nop 3
    s_cmp_ge_u32 s68, 8
    s_cbranch_scc0 L_xspin
    s_mov_b32 s71, 79872
    s_add_u32 m0, s92, 79872
    s_nop 0
    buffer_load_dwordx4 v100, s[36:39], s71 offen lds
    s_add_u32 m0, s92, 80896
    s_nop 0
    buffer_load_dwordx4 v101, s[36:39], s71 offen lds
    s_add_u32 m0, s92, 81920
    s_nop 0
    buffer_load_dwordx4 v102, s[36:39], s71 offen lds
    s_add_u32 m0, s92, 82944
    s_nop 0
    buffer_load_dwordx4 v103, s[36:39], s71 offen lds
    s_add_u32 m0, s92, 83968
    s_nop 0
    buffer_load_dwordx4 v104, s[36:39], s71 offen lds
    s_add_u32 m0, s92, 84992
    s_nop 0
    buffer_load_dwordx4 v105, s[36:39], s71 offen lds
    s_cbranch_vccnz L_d6_0
    s_add_u32 m0, s92, 86016
    s_nop 0
    buffer_load_dwordx4 v106, s[36:39], s71 offen lds
L_d6_0:
    s_cbranch_vccnz L_vw6_1
    s_waitcnt vmcnt(7)
    s_branch L_vwd_1
L_vw6_1:
    s_waitcnt vmcnt(6)
L_vwd_1:
    ds_read_b64_tr_b16 v[30:31], v108 offset:26624
    ds_read_b64_tr_b16 v[32:33], v110 offset:26624
    ds_read_b64_tr_b16 v[34:35], v109 offset:26624
    ds_read_b64_tr_b16 v[36:37], v111 offset:26624
    ds_read_b64_tr_b16 v[38:39], v108 offset:26688
    ds_read_b64_tr_b16 v[40:41], v110 offset:26688
    ds_read_b64_tr_b16 v[42:43], v109 offset:26688
    ds_read_b64_tr_b16 v[44:45], v111 offset:26688
    ds_read_b64_tr_b16 v[46:47], v108 offset:26752
    ds_read_b64_tr_b16 v[48:49], v110 offset:26752
    ds_read_b64_tr_b16 v[50:51], v109 offset:26752
    ds_read_b64_tr_b16 v[52:53], v111 offset:26752
    s_cbranch_vccnz L_r6_1
    ds_read_b64_tr_b16 v[54:55], v108 offset:26816
    ds_read_b64_tr_b16 v[56:57], v110 offset:26816
L_r6_1:
    s_waitcnt lgkmcnt(12)
    s_mov_b32 s71, 106496
    s_add_u32 m0, s92, 0
    v_mfma_f32_16x16x32_bf16 v[208:211], v[152:155], v[2:5], v[208:211]
    buffer_load_dwordx4 v100, s[36:39], s71 offen lds
    s_add_u32 m0, s92, 1024
    v_mfma_f32_16x16x32_bf16 v[212:215], v[152:155], v[6:9], v[212:215]
    buffer_load_dwordx4 v101, s[36:39], s71 offen lds
    s_add_u32 m0, s92, 2048
    v_mfma_f32_16x16x32_bf16 v[216:219], v[152:155], v[10:13], v[216:219]
    buffer_load_dwordx4 v102, s[36:39], s71 offen lds
    s_add_u32 m0, s92, 3072
    v_mfma_f32_16x16x32_bf16 v[220:223], v[152:155], v[14:17], v[220:223]
    buffer_load_dwordx4 v103, s[36:39], s71 offen lds
    s_add_u32 m0, s92, 4096
    v_mfma_f32_16x16x32_bf16 v[224:227], v[152:155], v[18:21], v[224:227]
    buffer_load_dwordx4 v104, s[36:39], s71 offen lds
    s_add_u32 m0, s92, 5120
    v_mfma_f32_16x16x32_bf16 v[228:231], v[152:155], v[22:25], v[228:231]
    buffer_load_dwordx4 v105, s[36:39], s71 offen lds
    s_cbranch_vccnz L_m6_1
    s_add_u32 m0, s92, 6144
    v_mfma_f32_16x16x32_bf16 v[232:235], v[152:155], v[26:29], v[232:235]
    buffer_load_dwordx4 v106, s[36:39], s71 offen lds
L_m6_1:
    s_cbranch_vccnz L_vw6_2
    s_waitcnt vmcnt(7)
    s_branch L_vwd_2
L_vw6_2:
    s_waitcnt vmcnt(6)
L_vwd_2:
    ds_read_b64_tr_b16 v[2:3], v112 offset:0
    ds_read_b64_tr_b16 v[4:5], v114 offset:0
    ds_read_b64_tr_b16 v[6:7], v113 offset:0
    ds_read_b64_tr_b16 v[8:9], v115 offset:0
    ds_read_b64_tr_b16 v[10:11], v112 offset:64
    ds_read_b64_tr_b16 v[12:13], v114 offset:64
    ds_read_b64_tr_b16 v[14:15], v113 offset:64
    ds_read_b64_tr_b16 v[16:17], v115 offset:64
    ds_read_b64_tr_b16 v[18:19], v112 offset:128
    ds_read_b64_tr_b16 v[20:21], v114 offset:128
    ds_read_b64_tr_b16 v[22:23], v113 offset:128
    ds_read_b64_tr_b16 v[24:25], v115 offset:128
    s_cbranch_vccnz L_r6_2
    ds_read_b64_tr_b16 v[26:27], v112 offset:192
    ds_read_b64_tr_b16 v[28:29], v114 offset:192
L_r6_2:
    s_waitcnt lgkmcnt(12)
    s_mov_b32 s71, 133120
    s_add_u32 m0, s92, 26624
    v_mfma_f32_16x16x32_bf16 v[208:211], v[156:159], v[30:33], v[208:211]
    buffer_load_dwordx4 v100, s[36:39], s71 offen lds
    s_add_u32 m0, s92, 27648
    v_mfma_f32_16x16x32_bf16 v[212:215], v[156:159], v[34:37], v[212:215]
    buffer_load_dwordx4 v101, s[36:39], s71 offen lds
    s_add_u32 m0, s92, 28672
    v_mfma_f32_16x16x32_bf16 v[216:219], v[156:159], v[38:41], v[216:219]
    buffer_load_dwordx4 v102, s[36:39], s71 offen lds
    s_add_u32 m0, s92, 29696
    v_mfma_f32_16x16x32_bf16 v[220:223], v[156:159], v[42:45], v[220:223]
    buffer_load_dwordx4 v103, s[36:39], s71 offen lds
    s_add_u32 m0, s92, 30720
    v_mfma_f32_16x16x32_bf16 v[224:227], v[156:159], v[46:49], v[224:227]
    buffer_load_dwordx4 v104, s[36:39], s71 offen lds
    s_add_u32 m0, s92, 31744
    v_mfma_f32_16x16x32_bf16 v[228:231], v[156:159], v[50:53], v[228:231]
    buffer_load_dwordx4 v105, s[36:39], s71 offen lds
    s_cbranch_vccnz L_m6_2
    s_add_u32 m0, s92, 32768
    v_mfma_f32_16x16x32_bf16 v[232:235], v[156:159], v[54:57], v[232:235]
    buffer_load_dwordx4 v106, s[36:39], s71 offen lds
L_m6_2:
    s_cbranch_vccnz L_vw6_3
    s_waitcnt vmcnt(7)
    s_branch L_vwd_3
L_vw6_3:
    s_waitcnt vmcnt(6)
L_vwd_3:
    ds_read_b64_tr_b16 v[30:31], v112 offset:26624
    ds_read_b64_tr_b16 v[32:33], v114 offset:26624
    ds_read_b64_tr_b16 v[34:35], v113 offset:26624
    ds_read_b64_tr_b16 v[36:37], v115 offset:26624
    ds_read_b64_tr_b16 v[38:39], v112 offset:26688
    ds_read_b64_tr_b16 v[40:41], v114 offset:26688
    ds_read_b64_tr_b16 v[42:43], v113 offset:26688
    ds_read_b64_tr_b16 v[44:45], v115 offset:26688
    ds_read_b64_tr_b16 v[46:47], v112 offset:26752
    ds_read_b64_tr_b16 v[48:49], v114 offset:26752
    ds_read_b64_tr_b16 v[50:51], v113 offset:26752
    ds_read_b64_tr_b16 v[52:53], v115 offset:26752
    s_cbranch_vccnz L_r6_3
    ds_read_b64_tr_b16 v[54:55], v112 offset:26816
    ds_read_b64_tr_b16 v[56:57], v114 offset:26816
L_r6_3:
    s_waitcnt lgkmcnt(12)
    s_mov_b32 s71, 159744
    s_add_u32 m0, s92, 53248
    v_mfma_f32_16x16x32_bf16 v[208:211], v[160:163], v[2:5], v[208:211]
    buffer_load_dwordx4 v100, s[36:39], s71 offen lds
    s_add_u32 m0, s92, 54272
    v_mfma_f32_16x16x32_bf16 v[212:215], v[160:163], v[6:9], v[212:215]
    buffer_load_dwordx4 v101, s[36:39], s71 offen lds
    s_add_u32 m0, s92, 55296
    v_mfma_f32_16x16x32_bf16 v[216:219], v[160:163], v[10:13], v[216:219]
    buffer_load_dwordx4 v102, s[36:39], s71 offen lds
    s_add_u32 m0, s92, 56320
    v_mfma_f32_16x16x32_bf16 v[220:223], v[160:163], v[14:17], v[220:223]
    buffer_load_dwordx4 v103, s[36:39], s71 offen lds
    s_add_u32 m0, s92, 57344
    v_mfma_f32_16x16x32_bf16 v[224:227], v[160:163], v[18:21], v[224:227]
    buffer_load_dwordx4 v104, s[36:39], s71 offen lds
    s_add_u32 m0, s92, 58368
    v_mfma_f32_16x16x32_bf16 v[228:231], v[160:163], v[22:25], v[228:231]
    buffer_load_dwordx4 v105, s[36:39], s71 offen lds
    s_cbranch_vccnz L_m6_3
    s_add_u32 m0, s92, 59392
    v_mfma_f32_16x16x32_bf16 v[232:235], v[160:163], v[26:29], v[232:235]
    buffer_load_dwordx4 v106, s[36:39], s71 offen lds
L_m6_3:
    s_cbranch_vccnz L_vw6_4
    s_waitcnt vmcnt(7)
    s_branch L_vwd_4
L_vw6_4:
    s_waitcnt vmcnt(6)
L_vwd_4:
    ds_read_b64_tr_b16 v[2:3], v108 offset:0
    ds_read_b64_tr_b16 v[4:5], v110 offset:0
    ds_read_b64_tr_b16 v[6:7], v109 offset:0
    ds_read_b64_tr_b16 v[8:9], v111 offset:0
    ds_read_b64_tr_b16 v[10:11], v108 offset:64
    ds_read_b64_tr_b16 v[12:13], v110 offset:64
    ds_read_b64_tr_b16 v[14:15], v109 offset:64
    ds_read_b64_tr_b16 v[16:17], v111 offset:64
    ds_read_b64_tr_b16 v[18:19], v108 offset:128
    ds_read_b64_tr_b16 v[20:21], v110 offset:128
    ds_read_b64_tr_b16 v[22:23], v109 offset:128
    ds_read_b64_tr_b16 v[24:25], v111 offset:128
    s_cbranch_vccnz L_r6_4
    ds_read_b64_tr_b16 v[26:27], v108 offset:192
    ds_read_b64_tr_b16 v[28:29], v110 offset:192
L_r6_4:
    s_waitcnt lgkmcnt(12)
    s_mov_b32 s71, 186368
    s_add_u32 m0, s92, 79872
    v_mfma_f32_16x16x32_bf16 v[208:211], v[164:167], v[30:33], v[208:211]
    buffer_load_dwordx4 v100, s[36:39], s71 offen lds
    s_add_u32 m0, s92, 80896
    v_mfma_f32_16x16x32_bf16 v[212:215], v[164:167], v[34:37], v[212:215]
    buffer_load_dwordx4 v101, s[36:39], s71 offen lds
    s_add_u32 m0, s92, 81920
    v_mfma_f32_16x16x32_bf16 v[216:219], v[164:167], v[38:41], v[216:219]
    buffer_load_dwordx4 v102, s[36:39], s71 offen lds
    s_add_u32 m0, s92, 82944
    v_mfma_f32_16x16x32_bf16 v[220:223], v[164:167], v[42:45], v[220:223]
    buffer_load_dwordx4 v103, s[36:39], s71 offen lds
    s_add_u32 m0, s92, 83968
    v_mfma_f32_16x16x32_bf16 v[224:227], v[164:167], v[46:49], v[224:227]
    buffer_load_dwordx4 v104, s[36:39], s71 offen lds
    s_add_u32 m0, s92, 84992
    v_mfma_f32_16x16x32_bf16 v[228:231], v[164:167], v[50:53], v[228:231]
    buffer_load_dwordx4 v105, s[36:39], s71 offen lds
    s_cbranch_vccnz L_m6_4
    s_add_u32 m0, s92, 86016
    v_mfma_f32_16x16x32_bf16 v[232:235], v[164:167], v[54:57], v[232:235]
    buffer_load_dwordx4 v106, s[36:39], s71 offen lds
L_m6_4:
    s_cbranch_vccnz L_vw6_5
    s_waitcnt vmcnt(7)
    s_branch L_vwd_5
L_vw6_5:
    s_waitcnt vmcnt(6)
L_vwd_5:
    ds_read_b64_tr_b16 v[30:31], v108 offset:26624
    ds_read_b64_tr_b16 v[32:33], v110 offset:26624
    ds_read_b64_tr_b16 v[34:35], v109 offset:26624
    ds_read_b64_tr_b16 v[36:37], v111 offset:26624
    ds_read_b64_tr_b16 v[38:39], v108 offset:26688
    ds_read_b64_tr_b16 v[40:41], v110 offset:26688
    ds_read_b64_tr_b16 v[42:43], v109 offset:26688
    ds_read_b64_tr_b16 v[44:45], v111 offset:26688
    ds_read_b64_tr_b16 v[46:47], v108 offset:26752
    ds_read_b64_tr_b16 v[48:49], v110 offset:26752
    ds_read_b64_tr_b16 v[50:51], v109 offset:26752
    ds_read_b64_tr_b16 v[52:53], v111 offset:26752
    s_cbranch_vccnz L_r6_5
    ds_read_b64_tr_b16 v[54:55], v108 offset:26816
    ds_read_b64_tr_b16 v[56:57], v110 offset:26816
L_r6_5:
    s_waitcnt lgkmcnt(12)
    s_mov_b32 s71, 212992
    s_add_u32 m0, s92, 0
    v_mfma_f32_16x16x32_bf16 v[208:211], v[168:171], v[2:5], v[208:211]
    buffer_load_dwordx4 v100, s[36:39], s71 offen lds
    s_add_u32 m0, s92, 1024
    v_mfma_f32_16x16x32_bf16 v[212:215], v[168:171], v[6:9], v[212:215]
    buffer_load_dwordx4 v101, s[36:39], s71 offen lds
    s_add_u32 m0, s92, 2048
    v_mfma_f32_16x16x32_bf16 v[216:219], v[168:171], v[10:13], v[216:219]
    buffer_load_dwordx4 v102, s[36:39], s71 offen lds
    s_add_u32 m0, s92, 3072
    v_mfma_f32_16x16x32_bf16 v[220:223], v[168:171], v[14:17], v[220:223]
    buffer_load_dwordx4 v103, s[36:39], s71 offen lds
    s_add_u32 m0, s92, 4096
    v_mfma_f32_16x16x32_bf16 v[224:227], v[168:171], v[18:21], v[224:227]
    buffer_load_dwordx4 v104, s[36:39], s71 offen lds
    s_add_u32 m0, s92, 5120
    v_mfma_f32_16x16x32_bf16 v[228:231], v[168:171], v[22:25], v[228:231]
    buffer_load_dwordx4 v105, s[36:39], s71 offen lds
    s_cbranch_vccnz L_m6_5
    s_add_u32 m0, s92, 6144
    v_mfma_f32_16x16x32_bf16 v[232:235], v[168:171], v[26:29], v[232:235]
    buffer_load_dwordx4 v106, s[36:39], s71 offen lds
L_m6_5:
    s_cbranch_vccnz L_vw6_6
    s_waitcnt vmcnt(7)
    s_branch L_vwd_6
L_vw6_6:
    s_waitcnt vmcnt(6)
L_vwd_6:
    ds_read_b64_tr_b16 v[2:3], v112 offset:0
    ds_read_b64_tr_b16 v[4:5], v114 offset:0
    ds_read_b64_tr_b16 v[6:7], v113 offset:0
    ds_read_b64_tr_b16 v[8:9], v115 offset:0
    ds_read_b64_tr_b16 v[10:11], v112 offset:64
    ds_read_b64_tr_b16 v[12:13], v114 offset:64
    ds_read_b64_tr_b16 v[14:15], v113 offset:64
    ds_read_b64_tr_b16 v[16:17], v115 offset:64
    ds_read_b64_tr_b16 v[18:19], v112 offset:128
    ds_read_b64_tr_b16 v[20:21], v114 offset:128
    ds_read_b64_tr_b16 v[22:23], v113 offset:128
    ds_read_b64_tr_b16 v[24:25], v115 offset:128
    s_cbranch_vccnz L_r6_6
    ds_read_b64_tr_b16 v[26:27], v112 offset:192
    ds_read_b64_tr_b16 v[28:29], v114 offset:192
L_r6_6:
    s_waitcnt lgkmcnt(12)
    s_mov_b32 s71, 239616
    s_add_u32 m0, s92, 26624
    v_mfma_f32_16x16x32_bf16 v[208:211], v[172:175], v[30:33], v[208:211]
    buffer_load_dwordx4 v100, s[36:39], s71 offen lds
    s_add_u32 m0, s92, 27648
    v_mfma_f32_16x16x32_bf16 v[212:215], v[172:175], v[34:37], v[212:215]
    buffer_load_dwordx4 v101, s[36:39], s71 offen lds
    s_add_u32 m0, s92, 28672
    v_mfma_f32_16x16x32_bf16 v[216:219], v[172:175], v[38:41], v[216:219]
    buffer_load_dwordx4 v102, s[36:39], s71 offen lds
    s_add_u32 m0, s92, 29696
    v_mfma_f32_16x16x32_bf16 v[220:223], v[172:175], v[42:45], v[220:223]
    buffer_load_dwordx4 v103, s[36:39], s71 offen lds
    s_add_u32 m0, s92, 30720
    v_mfma_f32_16x16x32_bf16 v[224:227], v[172:175], v[46:49], v[224:227]
    buffer_load_dwordx4 v104, s[36:39], s71 offen lds
    s_add_u32 m0, s92, 31744
    v_mfma_f32_16x16x32_bf16 v[228:231], v[172:175], v[50:53], v[228:231]
    buffer_load_dwordx4 v105, s[36:39], s71 offen lds
    s_cbranch_vccnz L_m6_6
    s_add_u32 m0, s92, 32768
    v_mfma_f32_16x16x32_bf16 v[232:235], v[172:175], v[54:57], v[232:235]
    buffer_load_dwordx4 v106, s[36:39], s71 offen lds
L_m6_6:
    s_cbranch_vccnz L_vw6_7
    s_waitcnt vmcnt(7)
    s_branch L_vwd_7
L_vw6_7:
    s_waitcnt vmcnt(6)
L_vwd_7:
    ds_read_b64_tr_b16 v[30:31], v112 offset:26624
    ds_read_b64_tr_b16 v[32:33], v114 offset:26624
    ds_read_b64_tr_b16 v[34:35], v113 offset:26624
    ds_read_b64_tr_b16 v[36:37], v115 offset:26624
    ds_read_b64_tr_b16 v[38:39], v112 offset:26688
    ds_read_b64_tr_b16 v[40:41], v114 offset:26688
    ds_read_b64_tr_b16 v[42:43], v113 offset:26688
    ds_read_b64_tr_b16 v[44:45], v115 offset:26688
    ds_read_b64_tr_b16 v[46:47], v112 offset:26752
    ds_read_b64_tr_b16 v[48:49], v114 offset:26752
    ds_read_b64_tr_b16 v[50:51], v113 offset:26752
    ds_read_b64_tr_b16 v[52:53], v115 offset:26752
    s_cbranch_vccnz L_r6_7
    ds_read_b64_tr_b16 v[54:55], v112 offset:26816
    ds_read_b64_tr_b16 v[56:57], v114 offset:26816
L_r6_7:
    s_waitcnt lgkmcnt(12)
    s_mov_b32 s71, 266240
    s_add_u32 m0, s92, 53248
    v_mfma_f32_16x16x32_bf16 v[208:211], v[176:179], v[2:5], v[208:211]
    buffer_load_dwordx4 v100, s[36:39], s71 offen lds
    s_add_u32 m0, s92, 54272
    v_mfma_f32_16x16x32_bf16 v[212:215], v[176:179], v[6:9], v[212:215]
    buffer_load_dwordx4 v101, s[36:39], s71 offen lds
    s_add_u32 m0, s92, 55296
    v_mfma_f32_16x16x32_bf16 v[216:219], v[176:179], v[10:13], v[216:219]
    buffer_load_dwordx4 v102, s[36:39], s71 offen lds
    s_add_u32 m0, s92, 56320
    v_mfma_f32_16x16x32_bf16 v[220:223], v[176:179], v[14:17], v[220:223]
    buffer_load_dwordx4 v103, s[36:39], s71 offen lds
    s_add_u32 m0, s92, 57344
    v_mfma_f32_16x16x32_bf16 v[224:227], v[176:179], v[18:21], v[224:227]
    buffer_load_dwordx4 v104, s[36:39], s71 offen lds
    s_add_u32 m0, s92, 58368
    v_mfma_f32_16x16x32_bf16 v[228:231], v[176:179], v[22:25], v[228:231]
    buffer_load_dwordx4 v105, s[36:39], s71 offen lds
    s_cbranch_vccnz L_m6_7
    s_add_u32 m0, s92, 59392
    v_mfma_f32_16x16x32_bf16 v[232:235], v[176:179], v[26:29], v[232:235]
    buffer_load_dwordx4 v106, s[36:39], s71 offen lds
L_m6_7:
    s_cbranch_vccnz L_vw6_8
    s_waitcnt vmcnt(7)
    s_branch L_vwd_8
L_vw6_8:
    s_waitcnt vmcnt(6)
L_vwd_8:
    ds_read_b64_tr_b16 v[2:3], v108 offset:0
    ds_read_b64_tr_b16 v[4:5], v110 offset:0
    ds_read_b64_tr_b16 v[6:7], v109 offset:0
    ds_read_b64_tr_b16 v[8:9], v111 offset:0
    ds_read_b64_tr_b16 v[10:11], v108 offset:64
    ds_read_b64_tr_b16 v[12:13], v110 offset:64
    ds_read_b64_tr_b16 v[14:15], v109 offset:64
    ds_read_b64_tr_b16 v[16:17], v111 offset:64
    ds_read_b64_tr_b16 v[18:19], v108 offset:128
    ds_read_b64_tr_b16 v[20:21], v110 offset:128
    ds_read_b64_tr_b16 v[22:23], v109 offset:128
    ds_read_b64_tr_b16 v[24:25], v111 offset:128
    s_cbranch_vccnz L_r6_8
    ds_read_b64_tr_b16 v[26:27], v108 offset:192
    ds_read_b64_tr_b16 v[28:29], v110 offset:192
L_r6_8:
    s_waitcnt lgkmcnt(12)
    s_mov_b32 s71, 292864
    s_add_u32 m0, s92, 79872
    v_mfma_f32_16x16x32_bf16 v[208:211], v[180:183], v[30:33], v[208:211]
    buffer_load_dwordx4 v100, s[36:39], s71 offen lds
    s_add_u32 m0, s92, 80896
    v_mfma_f32_16x16x32_bf16 v[212:215], v[180:183], v[34:37], v[212:215]
    buffer_load_dwordx4 v101, s[36:39], s71 offen lds
    s_add_u32 m0, s92, 81920
    v_mfma_f32_16x16x32_bf16 v[216:219], v[180:183], v[38:41], v[216:219]
    buffer_load_dwordx4 v102, s[36:39], s71 offen lds
    s_add_u32 m0, s92, 82944
    v_mfma_f32_16x16x32_bf16 v[220:223], v[180:183], v[42:45], v[220:223]
    buffer_load_dwordx4 v103, s[36:39], s71 offen lds
    s_add_u32 m0, s92, 83968
    v_mfma_f32_16x16x32_bf16 v[224:227], v[180:183], v[46:49], v[224:227]
    buffer_load_dwordx4 v104, s[36:39], s71 offen lds
    s_add_u32 m0, s92, 84992
    v_mfma_f32_16x16x32_bf16 v[228:231], v[180:183], v[50:53], v[228:231]
    buffer_load_dwordx4 v105, s[36:39], s71 offen lds
    s_cbranch_vccnz L_m6_8
    s_add_u32 m0, s92, 86016
    v_mfma_f32_16x16x32_bf16 v[232:235], v[180:183], v[54:57], v[232:235]
    buffer_load_dwordx4 v106, s[36:39], s71 offen lds
L_m6_8:
    s_cbranch_vccnz L_vw6_9
    s_waitcnt vmcnt(7)
    s_branch L_vwd_9
L_vw6_9:
    s_waitcnt vmcnt(6)
L_vwd_9:
    ds_read_b64_tr_b16 v[30:31], v108 offset:26624
    ds_read_b64_tr_b16 v[32:33], v110 offset:26624
    ds_read_b64_tr_b16 v[34:35], v109 offset:26624
    ds_read_b64_tr_b16 v[36:37], v111 offset:26624
    ds_read_b64_tr_b16 v[38:39], v108 offset:26688
    ds_read_b64_tr_b16 v[40:41], v110 offset:26688
    ds_read_b64_tr_b16 v[42:43], v109 offset:26688
    ds_read_b64_tr_b16 v[44:45], v111 offset:26688
    ds_read_b64_tr_b16 v[46:47], v108 offset:26752
    ds_read_b64_tr_b16 v[48:49], v110 offset:26752
    ds_read_b64_tr_b16 v[50:51], v109 offset:26752
    ds_read_b64_tr_b16 v[52:53], v111 offset:26752
    s_cbranch_vccnz L_r6_9
    ds_read_b64_tr_b16 v[54:55], v108 offset:26816
    ds_read_b64_tr_b16 v[56:57], v110 offset:26816
L_r6_9:
    s_waitcnt lgkmcnt(12)
    s_mov_b32 s71, 319488
    s_add_u32 m0, s92, 0
    v_mfma_f32_16x16x32_bf16 v[208:211], v[184:187], v[2:5], v[208:211]
    buffer_load_dwordx4 v100, s[36:39], s71 offen lds
    s_add_u32 m0, s92, 1024
    v_mfma_f32_16x16x32_bf16 v[212:215], v[184:187], v[6:9], v[212:215]
    buffer_load_dwordx4 v101, s[36:39], s71 offen lds
    s_add_u32 m0, s92, 2048
    v_mfma_f32_16x16x32_bf16 v[216:219], v[184:187], v[10:13], v[216:219]
    buffer_load_dwordx4 v102, s[36:39], s71 offen lds
    s_add_u32 m0, s92, 3072
    v_mfma_f32_16x16x32_bf16 v[220:223], v[184:187], v[14:17], v[220:223]
    buffer_load_dwordx4 v103, s[36:39], s71 offen lds
    s_add_u32 m0, s92, 4096
    v_mfma_f32_16x16x32_bf16 v[224:227], v[184:187], v[18:21], v[224:227]
    buffer_load_dwordx4 v104, s[36:39], s71 offen lds
    s_add_u32 m0, s92, 5120
    v_mfma_f32_16x16x32_bf16 v[228:231], v[184:187], v[22:25], v[228:231]
    buffer_load_dwordx4 v105, s[36:39], s71 offen lds
    s_cbranch_vccnz L_m6_9
    s_add_u32 m0, s92, 6144
    v_mfma_f32_16x16x32_bf16 v[232:235], v[184:187], v[26:29], v[232:235]
    buffer_load_dwordx4 v106, s[36:39], s71 offen lds
L_m6_9:
    s_cbranch_vccnz L_vw6_10
    s_waitcnt vmcnt(7)
    s_branch L_vwd_10
L_vw6_10:
    s_waitcnt vmcnt(6)
L_vwd_10:
    ds_read_b64_tr_b16 v[2:3], v112 offset:0
    ds_read_b64_tr_b16 v[4:5], v114 offset:0
    ds_read_b64_tr_b16 v[6:7], v113 offset:0
    ds_read_b64_tr_b16 v[8:9], v115 offset:0
    ds_read_b64_tr_b16 v[10:11], v112 offset:64
    ds_read_b64_tr_b16 v[12:13], v114 offset:64
    ds_read_b64_tr_b16 v[14:15], v113 offset:64
    ds_read_b64_tr_b16 v[16:17], v115 offset:64
    ds_read_b64_tr_b16 v[18:19], v112 offset:128
    ds_read_b64_tr_b16 v[20:21], v114 offset:128
    ds_read_b64_tr_b16 v[22:23], v113 offset:128
    ds_read_b64_tr_b16 v[24:25], v115 offset:128
    s_cbranch_vccnz L_r6_10
    ds_read_b64_tr_b16 v[26:27], v112 offset:192
    ds_read_b64_tr_b16 v[28:29], v114 offset:192
L_r6_10:
    s_waitcnt lgkmcnt(12)
    v_mfma_f32_16x16x32_bf16 v[208:211], v[188:191], v[30:33], v[208:211]
    v_mfma_f32_16x16x32_bf16 v[212:215], v[188:191], v[34:37], v[212:215]
    v_mfma_f32_16x16x32_bf16 v[216:219], v[188:191], v[38:41], v[216:219]
    v_mfma_f32_16x16x32_bf16 v[220:223], v[188:191], v[42:45], v[220:223]
    v_mfma_f32_16x16x32_bf16 v[224:227], v[188:191], v[46:49], v[224:227]
    v_mfma_f32_16x16x32_bf16 v[228:231], v[188:191], v[50:53], v[228:231]
    s_cbranch_vccnz L_m6_10
    v_mfma_f32_16x16x32_bf16 v[232:235], v[188:191], v[54:57], v[232:235]
L_m6_10:
    s_waitcnt vmcnt(0)
    ds_read_b64_tr_b16 v[30:31], v112 offset:26624
    ds_read_b64_tr_b16 v[32:33], v114 offset:26624
    ds_read_b64_tr_b16 v[34:35], v113 offset:26624
    ds_read_b64_tr_b16 v[36:37], v115 offset:26624
    ds_read_b64_tr_b16 v[38:39], v112 offset:26688
    ds_read_b64_tr_b16 v[40:41], v114 offset:26688
    ds_read_b64_tr_b16 v[42:43], v113 offset:26688
    ds_read_b64_tr_b16 v[44:45], v115 offset:26688
    ds_read_b64_tr_b16 v[46:47], v112 offset:26752
    ds_read_b64_tr_b16 v[48:49], v114 offset:26752
    ds_read_b64_tr_b16 v[50:51], v113 offset:26752
    ds_read_b64_tr_b16 v[52:53], v115 offset:26752
    s_cbranch_vccnz L_r6_11
    ds_read_b64_tr_b16 v[54:55], v112 offset:26816
    ds_read_b64_tr_b16 v[56:57], v114 offset:26816
L_r6_11:
    s_waitcnt lgkmcnt(12)
    v_mfma_f32_16x16x32_bf16 v[208:211], v[192:195], v[2:5], v[208:211]
    v_mfma_f32_16x16x32_bf16 v[212:215], v[192:195], v[6:9], v[212:215]
    v_mfma_f32_16x16x32_bf16 v[216:219], v[192:195], v[10:13], v[216:219]
    v_mfma_f32_16x16x32_bf16 v[220:223], v[192:195], v[14:17], v[220:223]
    v_mfma_f32_16x16x32_bf16 v[224:227], v[192:195], v[18:21], v[224:227]
    v_mfma_f32_16x16x32_bf16 v[228:231], v[192:195], v[22:25], v[228:231]
    s_cbranch_vccnz L_m6_11
    v_mfma_f32_16x16x32_bf16 v[232:235], v[192:195], v[26:29], v[232:235]
L_m6_11:
    s_waitcnt vmcnt(0)
    ds_read_b64_tr_b16 v[2:3], v108 offset:0
    ds_read_b64_tr_b16 v[4:5], v110 offset:0
    ds_read_b64_tr_b16 v[6:7], v109 offset:0
    ds_read_b64_tr_b16 v[8:9], v111 offset:0
    ds_read_b64_tr_b16 v[10:11], v108 offset:64
    ds_read_b64_tr_b16 v[12:13], v110 offset:64
    ds_read_b64_tr_b16 v[14:15], v109 offset:64
    ds_read_b64_tr_b16 v[16:17], v111 offset:64
    ds_read_b64_tr_b16 v[18:19], v108 offset:128
    ds_read_b64_tr_b16 v[20:21], v110 offset:128
    ds_read_b64_tr_b16 v[22:23], v109 offset:128
    ds_read_b64_tr_b16 v[24:25], v111 offset:128
    s_cbranch_vccnz L_r6_12
    ds_read_b64_tr_b16 v[26:27], v108 offset:192
    ds_read_b64_tr_b16 v[28:29], v110 offset:192
L_r6_12:
    s_waitcnt lgkmcnt(12)
    v_mfma_f32_16x16x32_bf16 v[208:211], v[196:199], v[30:33], v[208:211]
    v_mfma_f32_16x16x32_bf16 v[212:215], v[196:199], v[34:37], v[212:215]
    v_mfma_f32_16x16x32_bf16 v[216:219], v[196:199], v[38:41], v[216:219]
    v_mfma_f32_16x16x32_bf16 v[220:223], v[196:199], v[42:45], v[220:223]
    v_mfma_f32_16x16x32_bf16 v[224:227], v[196:199], v[46:49], v[224:227]
    v_mfma_f32_16x16x32_bf16 v[228:231], v[196:199], v[50:53], v[228:231]
    s_cbranch_vccnz L_m6_12
    v_mfma_f32_16x16x32_bf16 v[232:235], v[196:199], v[54:57], v[232:235]
L_m6_12:
    s_waitcnt lgkmcnt(0)
    v_mfma_f32_16x16x32_bf16 v[208:211], v[200:203], v[2:5], v[208:211]
    v_mfma_f32_16x16x32_bf16 v[212:215], v[200:203], v[6:9], v[212:215]
    v_mfma_f32_16x16x32_bf16 v[216:219], v[200:203], v[10:13], v[216:219]
    v_mfma_f32_16x16x32_bf16 v[220:223], v[200:203], v[14:17], v[220:223]
    v_mfma_f32_16x16x32_bf16 v[224:227], v[200:203], v[18:21], v[224:227]
    v_mfma_f32_16x16x32_bf16 v[228:231], v[200:203], v[22:25], v[228:231]
    s_cbranch_vccnz L_m6_end
    v_mfma_f32_16x16x32_bf16 v[232:235], v[200:203], v[26:29], v[232:235]
L_m6_end:
    s_nop 1
    v_pk_mul_f32 v[126:127], v[208:209], v[208:209]
    v_pk_mul_f32 v[128:129], v[210:211], v[210:211]
    v_pk_mul_f32 v[130:131], v[212:213], v[212:213]
    v_pk_mul_f32 v[132:133], v[214:215], v[214:215]
    v_pk_fma_f32 v[126:127], v[126:127], v[244:245], v[246:247]
    v_pk_fma_f32 v[128:129], v[128:129], v[244:245], v[246:247]
    v_pk_fma_f32 v[130:131], v[130:131], v[244:245], v[246:247]
    v_pk_fma_f32 v[132:133], v[132:133], v[244:245], v[246:247]
    v_pk_mul_f32 v[126:127], v[126:127], v[208:209]
    v_pk_mul_f32 v[128:129], v[128:129], v[210:211]
    v_pk_mul_f32 v[130:131], v[130:131], v[212:213]
    v_pk_mul_f32 v[132:133], v[132:133], v[214:215]
    v_exp_f32 v126, v126
    v_exp_f32 v127, v127
    v_exp_f32 v128, v128
    v_exp_f32 v129, v129
    v_exp_f32 v130, v130
    v_exp_f32 v131, v131
    v_exp_f32 v132, v132
    v_exp_f32 v133, v133
    v_pk_mul_f32 v[208:209], v[208:209], v[236:237] op_sel:[0,0] op_sel_hi:[1,0]
    v_pk_mul_f32 v[210:211], v[210:211], v[236:237] op_sel:[0,0] op_sel_hi:[1,0]
    v_pk_mul_f32 v[212:213], v[212:213], v[236:237] op_sel:[0,1] op_sel_hi:[1,1]
    v_pk_mul_f32 v[214:215], v[214:215], v[236:237] op_sel:[0,1] op_sel_hi:[1,1]
    v_pk_add_f32 v[126:127], v[126:127], v[248:249]
    v_pk_add_f32 v[128:129], v[128:129], v[248:249]
    v_pk_add_f32 v[130:131], v[130:131], v[248:249]
    v_pk_add_f32 v[132:133], v[132:133], v[248:249]
    v_rcp_f32 v126, v126
    v_rcp_f32 v127, v127
    v_rcp_f32 v128, v128
    v_rcp_f32 v129, v129
    v_rcp_f32 v130, v130
    v_rcp_f32 v131, v131
    v_rcp_f32 v132, v132
    v_rcp_f32 v133, v133
    v_pk_mul_f32 v[122:123], v[126:127], v[208:209]
    v_pk_mul_f32 v[124:125], v[128:129], v[210:211]
    v_pk_fma_f32 v[122:123], v[130:131], v[212:213], v[122:123]
    v_pk_fma_f32 v[124:125], v[132:133], v[214:215], v[124:125]
    v_pk_mul_f32 v[126:127], v[216:217], v[216:217]
    v_pk_mul_f32 v[128:129], v[218:219], v[218:219]
    v_pk_mul_f32 v[130:131], v[220:221], v[220:221]
    v_pk_mul_f32 v[132:133], v[222:223], v[222:223]
    v_pk_fma_f32 v[126:127], v[126:127], v[244:245], v[246:247]
    v_pk_fma_f32 v[128:129], v[128:129], v[244:245], v[246:247]
    v_pk_fma_f32 v[130:131], v[130:131], v[244:245], v[246:247]
    v_pk_fma_f32 v[132:133], v[132:133], v[244:245], v[246:247]
    v_pk_mul_f32 v[126:127], v[126:127], v[216:217]
    v_pk_mul_f32 v[128:129], v[128:129], v[218:219]
    v_pk_mul_f32 v[130:131], v[130:131], v[220:221]
    v_pk_mul_f32 v[132:133], v[132:133], v[222:223]
    v_exp_f32 v126, v126
    v_exp_f32 v127, v127
    v_exp_f32 v128, v128
    v_exp_f32 v129, v129
    v_exp_f32 v130, v130
    v_exp_f32 v131, v131
    v_exp_f32 v132, v132
    v_exp_f32 v133, v133
    v_pk_mul_f32 v[216:217], v[216:217], v[238:239] op_sel:[0,0] op_sel_hi:[1,0]
    v_pk_mul_f32 v[218:219], v[218:219], v[238:239] op_sel:[0,0] op_sel_hi:[1,0]
    v_pk_mul_f32 v[220:221], v[220:221], v[238:239] op_sel:[0,1] op_sel_hi:[1,1]
    v_pk_mul_f32 v[222:223], v[222:223], v[238:239] op_sel:[0,1] op_sel_hi:[1,1]
    v_pk_add_f32 v[126:127], v[126:127], v[248:249]
    v_pk_add_f32 v[128:129], v[128:129], v[248:249]
    v_pk_add_f32 v[130:131], v[130:131], v[248:249]
    v_pk_add_f32 v[132:133], v[132:133], v[248:249]
    v_rcp_f32 v126, v126
    v_rcp_f32 v127, v127
    v_rcp_f32 v128, v128
    v_rcp_f32 v129, v129
    v_rcp_f32 v130, v130
    v_rcp_f32 v131, v131
    v_rcp_f32 v132, v132
    v_rcp_f32 v133, v133
    v_pk_fma_f32 v[122:123], v[126:127], v[216:217], v[122:123]
    v_pk_fma_f32 v[124:125], v[128:129], v[218:219], v[124:125]
    v_pk_fma_f32 v[122:123], v[130:131], v[220:221], v[122:123]
    v_pk_fma_f32 v[124:125], v[132:133], v[222:223], v[124:125]
    v_pk_mul_f32 v[126:127], v[224:225], v[224:225]
    v_pk_mul_f32 v[128:129], v[226:227], v[226:227]
    v_pk_mul_f32 v[130:131], v[228:229], v[228:229]
    v_pk_mul_f32 v[132:133], v[230:231], v[230:231]
    v_pk_fma_f32 v[126:127], v[126:127], v[244:245], v[246:247]
    v_pk_fma_f32 v[128:129], v[128:129], v[244:245], v[246:247]
    v_pk_fma_f32 v[130:131], v[130:131], v[244:245], v[246:247]
    v_pk_fma_f32 v[132:133], v[132:133], v[244:245], v[246:247]
    v_pk_mul_f32 v[126:127], v[126:127], v[224:225]
    v_pk_mul_f32 v[128:129], v[128:129], v[226:227]
    v_pk_mul_f32 v[130:131], v[130:131], v[228:229]
    v_pk_mul_f32 v[132:133], v[132:133], v[230:231]
    v_exp_f32 v126, v126
    v_exp_f32 v127, v127
    v_exp_f32 v128, v128
    v_exp_f32 v129, v129
    v_exp_f32 v130, v130
    v_exp_f32 v131, v131
    v_exp_f32 v132, v132
    v_exp_f32 v133, v133
    v_pk_mul_f32 v[224:225], v[224:225], v[240:241] op_sel:[0,0] op_sel_hi:[1,0]
    v_pk_mul_f32 v[226:227], v[226:227], v[240:241] op_sel:[0,0] op_sel_hi:[1,0]
    v_pk_mul_f32 v[228:229], v[228:229], v[240:241] op_sel:[0,1] op_sel_hi:[1,1]
    v_pk_mul_f32 v[230:231], v[230:231], v[240:241] op_sel:[0,1] op_sel_hi:[1,1]
    v_pk_add_f32 v[126:127], v[126:127], v[248:249]
    v_pk_add_f32 v[128:129], v[128:129], v[248:249]
    v_pk_add_f32 v[130:131], v[130:131], v[248:249]
    v_pk_add_f32 v[132:133], v[132:133], v[248:249]
    v_rcp_f32 v126, v126
    v_rcp_f32 v127, v127
    v_rcp_f32 v128, v128
    v_rcp_f32 v129, v129
    v_rcp_f32 v130, v130
    v_rcp_f32 v131, v131
    v_rcp_f32 v132, v132
    v_rcp_f32 v133, v133
    v_pk_fma_f32 v[122:123], v[126:127], v[224:225], v[122:123]
    v_pk_fma_f32 v[124:125], v[128:129], v[226:227], v[124:125]
    v_pk_fma_f32 v[122:123], v[130:131], v[228:229], v[122:123]
    v_pk_fma_f32 v[124:125], v[132:133], v[230:231], v[124:125]
    s_cmp_ge_u32 s65, 2
    s_cbranch_scc1 L_g6
    v_pk_mul_f32 v[126:127], v[232:233], v[232:233]
    v_pk_mul_f32 v[128:129], v[234:235], v[234:235]
    v_pk_fma_f32 v[126:127], v[126:127], v[244:245], v[246:247]
    v_pk_fma_f32 v[128:129], v[128:129], v[244:245], v[246:247]
    v_pk_mul_f32 v[126:127], v[126:127], v[232:233]
    v_pk_mul_f32 v[128:129], v[128:129], v[234:235]
    v_exp_f32 v126, v126
    v_exp_f32 v127, v127
    v_exp_f32 v128, v128
    v_exp_f32 v129, v129
    v_pk_mul_f32 v[232:233], v[232:233], v[242:243] op_sel:[0,0] op_sel_hi:[1,0]
    v_pk_mul_f32 v[234:235], v[234:235], v[242:243] op_sel:[0,0] op_sel_hi:[1,0]
    v_pk_add_f32 v[126:127], v[126:127], v[248:249]
    v_pk_add_f32 v[128:129], v[128:129], v[248:249]
    v_rcp_f32 v126, v126
    v_rcp_f32 v127, v127
    v_rcp_f32 v128, v128
    v_rcp_f32 v129, v129
    v_pk_fma_f32 v[122:123], v[126:127], v[232:233], v[122:123]
    v_pk_fma_f32 v[124:125], v[128:129], v[234:235], v[124:125]
L_g6:
    v_lshlrev_b32 v126, 8, v143
    s_lshl_b32 s68, s65, 2
    s_add_u32 s68, s68, 157888
    v_add_u32 v126, s68, v126
    v_add_f32_dpp v122, v122, v122 row_ror:8 row_mask:0xf bank_mask:0xf
    v_add_f32_dpp v123, v123, v123 row_ror:8 row_mask:0xf bank_mask:0xf
    v_add_f32_dpp v124, v124, v124 row_ror:8 row_mask:0xf bank_mask:0xf
    v_add_f32_dpp v125, v125, v125 row_ror:8 row_mask:0xf bank_mask:0xf
    v_add_f32_dpp v122, v122, v122 row_ror:4 row_mask:0xf bank_mask:0xf
    v_add_f32_dpp v123, v123, v123 row_ror:4 row_mask:0xf bank_mask:0xf
    v_add_f32_dpp v124, v124, v124 row_ror:4 row_mask:0xf bank_mask:0xf
    v_add_f32_dpp v125, v125, v125 row_ror:4 row_mask:0xf bank_mask:0xf
    v_add_f32_dpp v122, v122, v122 row_ror:2 row_mask:0xf bank_mask:0xf
    v_add_f32_dpp v123, v123, v123 row_ror:2 row_mask:0xf bank_mask:0xf
    v_add_f32_dpp v124, v124, v124 row_ror:2 row_mask:0xf bank_mask:0xf
    v_add_f32_dpp v125, v125, v125 row_ror:2 row_mask:0xf bank_mask:0xf
    v_add_f32_dpp v122, v122, v122 row_ror:1 row_mask:0xf bank_mask:0xf
    v_add_f32_dpp v123, v123, v123 row_ror:1 row_mask:0xf bank_mask:0xf
    v_add_f32_dpp v124, v124, v124 row_ror:1 row_mask:0xf bank_mask:0xf
    v_add_f32_dpp v125, v125, v125 row_ror:1 row_mask:0xf bank_mask:0xf
    s_mov_b32 exec_lo, 0x00010001
    s_mov_b32 exec_hi, 0x00010001
    ds_write_b32 v126, v122 offset:0
    ds_write_b32 v126, v123 offset:64
    ds_write_b32 v126, v124 offset:128
    ds_write_b32 v126, v125 offset:192
    s_mov_b64 exec, -1
    s_waitcnt lgkmcnt(0)
L_join:
    s_barrier
    s_cmp_lg_u32 s64, 0
    s_cbranch_scc1 L_end
    s_mov_b32 exec_lo, 0xffff
    s_mov_b32 exec_hi, 0
    v_lshlrev_b32 v126, 6, v0
    v_add_u32 v126, 157888, v126
    ds_read_b128 v[8:11], v126
    ds_read_b64 v[12:13], v126 offset:16
    s_mov_b32 s60, s20
    s_mov_b32 s61, s21
    s_mov_b32 s62, 8192
    s_mov_b32 s63, 0x20000
    s_lshl_b32 s66, s66, 16
    s_lshl_b32 s68, s2, 5
    v_lshlrev_b32 v127, 1, v0
    v_add_u32 v127, s68, v127
    s_waitcnt lgkmcnt(0)
    v_add_f32 v8, v8, v9
    v_add_f32 v10, v10, v11
    v_add_f32 v12, v12, v13
    v_add_f32 v8, v8, v10
    v_add_f32 v12, s66, v12
    v_add_f32 v8, v8, v12
    v_cvt_pk_bf16_f32 v8, v8, v8
    buffer_store_short v8, v127, s[60:63], 0 offen
L_end:
    s_endpgm
.section .rodata,"a"
.p2align 6
.amdhsa_kernel standalone__deep_cross_xdeepfm__recsys_kernel
  .amdhsa_next_free_vgpr 256
  .amdhsa_next_free_sgpr 102
  .amdhsa_accum_offset 256
  .amdhsa_group_segment_fixed_size 0
  .amdhsa_kernarg_size 88
  .amdhsa_user_sgpr_count 2
  .amdhsa_user_sgpr_kernarg_segment_ptr 1
  .amdhsa_system_sgpr_workgroup_id_x 1
  .amdhsa_ieee_mode 0
.end_amdhsa_kernel
```
